```python
import torch

def _softmax(x, axis=-1):
    return torch.softmax(x, dim=axis)

def _gelu(x):
    return torch.nn.functional.gelu(x, approximate='tanh')

def _silu(x):
    return torch.nn.functional.silu(x)

def _sigmoid(x):
    return torch.sigmoid(x)

def _layernorm(x, axis=-1, eps=1e-05):
    m = x.mean(dim=axis, keepdim=True)
    v = x.var(dim=axis, keepdim=True, unbiased=False)
    return (x - m) / torch.sqrt(v + eps)

def _scatter_add(tgt, idx, src, axis=0):
    return tgt.clone().index_add_(axis, idx, src)

def _segment_sum(src, seg, n):
    out = torch.zeros((n,) + src.shape[1:], dtype=src.dtype)
    return out.index_add_(0, seg, src)

def _pad(x, pw):
    flat = tuple((v for pair in reversed(pw) for v in pair))
    return torch.nn.functional.pad(x, flat)
kernel_name = 'gather_scatter__molecular_angular_painn__graph'

def setup_inputs():

    _w = lambda a: (lambda t: t.to(torch.bfloat16) if t.is_floating_point() else t)(torch.as_tensor(a))
    N, deg, D = (25000, 16, 128)
    n_rbf = max(16, 4)
    E = N * deg
    cutoff = 5.0
    freqs = (torch.arange(1, n_rbf + 1) * torch.pi / cutoff).to(float)
    return {'sv': _w((lambda *s: torch.randn(*s, dtype=torch.bfloat16) * 0.4)(N, 4, D) * 0.3), 'pos': _w((lambda *s: torch.randn(*s, dtype=torch.bfloat16) * 3.2)(N, 3) * 1.2), 'src': _w((lambda lo, hi, *s: torch.randint(lo, hi, s))(0, N, E).to(torch.int64)), 'dst': _w((lambda lo, hi, *s: torch.randint(lo, hi, s))(0, N, E).to(torch.int64)), 'freqs': _w(freqs), 'w_phi1': _w((lambda *s: torch.randn(*s, dtype=torch.bfloat16) * 3.2)(D, D) / D ** 0.5), 'w_phi2': _w((lambda *s: torch.randn(*s, dtype=torch.bfloat16) * 3.2)(D, 3 * D) / D ** 0.5), 'w_rbf': _w((lambda *s: torch.randn(*s, dtype=torch.bfloat16) * 3.2)(n_rbf, 3 * D) / n_rbf ** 0.5)}

def reference(sv, pos, src, dst, freqs, w_phi1, w_phi2, w_rbf):
    N, _, D = sv.shape
    E = src.shape[0]
    PI, cutoff = (3.141592653589793, 5.0)
    s, v = (sv[:, 0, :].clone(), sv[:, 1:, :].clone())
    r_vec = pos[src] - pos[dst]
    d = torch.sqrt((r_vec * r_vec).sum(-1) + 1e-08)
    r_hat = r_vec / d[:, None]
    rbf = torch.sin(d[:, None] * freqs[None, :]) / d[:, None]
    fcut = 0.5 * (torch.cos(PI * d / cutoff) + 1.0)
    fcut = torch.where(d < cutoff, fcut, 0.0 * d)
    Wf = rbf @ w_rbf * fcut[:, None]
    phi = (_silu(s @ w_phi1) @ w_phi2)[src]
    m = phi * Wf
    m_s, m_vv, m_vr = (m[:, :D].clone(), m[:, D:2 * D].clone(), m[:, 2 * D:].clone())
    ds = _segment_sum(m_s, dst, N)
    dv_e = m_vv[:, None, :] * v[src] + m_vr[:, None, :] * r_hat[:, :, None]
    dv = _segment_sum(dv_e.reshape(E, 3 * D), dst, N).reshape(N, 3, D)
    return sv + torch.concatenate([ds[:, None, :], dv], axis=1)
```

```asm
; @launch kernel=painn_fused_kernel grid=(256,1,1) block=(512,1,1) lds=163136
.amdgcn_target "amdgcn-amd-amdhsa--gfx950"
.text
.globl painn_fused_kernel
.p2align 8
.type painn_fused_kernel,@function
painn_fused_kernel:
    s_cmp_ge_u32 s2, 256
    s_cbranch_scc1 k_end
    s_load_dwordx16 s[8:23], s[0:1], 0
    s_memrealtime s[6:7]
    s_load_dwordx2 s[24:25], s[0:1], 64
    s_load_dwordx2 s[26:27], s[0:1], 80
    v_lshrrev_b32 v40, 6, v0
    v_and_b32 v1, 63, v0
    v_readfirstlane_b32 s3, v40
    v_and_b32 v146, 15, v0
    v_bfe_u32 v147, v0, 4, 2
    v_mul_u32_u24 v56, 12, v0
    v_lshlrev_b32 v2, 4, v1
    s_mul_i32 s94, s2, 98
    s_mul_i32 s4, s2, 12500
    v_lshlrev_b32 v87, 4, v0
    v_and_b32 v145, 3, v0
    v_lshlrev_b32 v145, 3, v145
    v_mov_b32 v21, 1
    v_mov_b32 v80, 0
    s_mov_b32 s101, s94
    s_add_u32 s97, s4, 6144
    s_waitcnt lgkmcnt(0)
    s_lshr_b64 s[6:7], s[6:7], 6
    s_mov_b32 s99, s6
    s_sub_u32 s100, s6, 24
    s_cmp_ge_u32 s2, 128
    s_cbranch_scc1 k_noe1
    s_mov_b32 s68, s14
    s_mov_b32 s69, s15
    s_mov_b32 s70, 1600000
    s_mov_b32 s71, 0x00020000
    s_mov_b32 s64, s12
    s_mov_b32 s65, s13
    s_mov_b32 s66, 1600000
    s_mov_b32 s67, 0x00020000
    buffer_load_dwordx3 v[48:50], v56, s[68:71], s4 offen
    buffer_load_dwordx3 v[52:54], v56, s[68:71], s97 offen
    s_cmp_lg_u32 s3, 7
    s_cbranch_scc1 k_e0
    s_add_u32 s5, s4, 12288
    v_lshlrev_b32 v57, 2, v1
    buffer_load_dword v51, v57, s[68:71], s5 offen
    buffer_load_dword v43, v57, s[64:67], s5 offen
k_e0:
    buffer_load_dwordx3 v[40:42], v56, s[64:67], s4 offen
    buffer_load_dwordx3 v[44:46], v56, s[64:67], s97 offen
    v_mov_b32 v81, 0
    v_mov_b32 v82, 0xffff0000
    s_and_b32 s5, s99, 255
    s_mul_i32 s5, s5, 0x01010100
    s_xor_b32 s5, s5, s99
    v_lshrrev_b32 v83, v145, s5
    v_lshlrev_b32 v83, 24, v83
    v_or_b32 v83, 0xffffff, v83
    v_add_u32 v84, 65536, v87
    ds_write_b128 v84, v[80:83] offset:0
    ds_write_b128 v84, v[80:83] offset:8192
    ds_write_b128 v84, v[80:83] offset:16384
    ds_write_b128 v84, v[80:83] offset:24576
    v_min_u32 v58, 256, v0
    v_mov_b32 v88, 143360
    v_lshl_add_u32 v58, v58, 2, v88
    ds_write_b32 v58, v80
    s_waitcnt lgkmcnt(0)
    s_barrier
k_noe1:
    s_cmp_lt_u32 s2, 128
    s_cbranch_scc1 k_nocp
    s_getpc_b64 s[64:65]
k_cp:
    s_bfe_u32 s66, s2, 0x40003
    s_lshl_b32 s66, s66, 3
    s_add_u32 s66, s66, s3
    s_lshl_b32 s66, s66, 7
    s_min_u32 s66, s66, k_end-k_cp
    s_load_dword s87, s[64:65], s66
k_nocp:
    v_lshlrev_b32 v153, 1, v147
    v_xor_b32 v153, v153, v146
    v_lshlrev_b32 v153, 4, v153
    v_lshl_or_b32 v153, v147, 8, v153
    v_xor_b32 v154, 128, v153
    v_lshl_add_u32 v152, s3, 2, v147
    v_xor_b32 v58, v152, v146
    v_and_b32 v58, 15, v58
    v_lshlrev_b32 v58, 4, v58
    v_lshl_or_b32 v152, v152, 10, v58
    s_mov_b32 s28, s8
    s_mov_b32 s29, s9
    s_mov_b32 s30, 25600000
    s_mov_b32 s31, 0x00020000
    s_add_u32 s40, s26, 5242880
    s_addc_u32 s41, s27, 0
    s_mov_b32 s42, 6400000
    s_mov_b32 s43, 0x00020000
    s_mov_b32 s72, s18
    s_mov_b32 s73, s19
    s_mov_b32 s74, 32768
    s_mov_b32 s75, 0x00020000
    s_mov_b32 s32, s10
    s_mov_b32 s33, s11
    s_mov_b32 s34, 150000
    s_mov_b32 s35, 0x00020000
    s_mov_b32 s76, s20
    s_mov_b32 s77, s21
    s_mov_b32 s78, 98304
    s_mov_b32 s79, 0x00020000
    s_mov_b32 s80, s22
    s_mov_b32 s81, s23
    s_mov_b32 s82, 12288
    s_mov_b32 s83, 0x00020000
    s_load_dwordx8 s[56:63], s[16:17], 0
    s_bfe_u32 s5, s2, 0x50003
    s_cmp_ge_u32 s3, 5
    s_cbranch_scc1 k_pf1
    s_mul_i32 s5, s5, 4688
    buffer_load_dwordx4 v[148:151], v87, s[32:35], s5 offen
    s_branch k_pf2
k_pf1:
    s_mul_i32 s6, s5, 3072
    s_sub_u32 s6, s6, 5120
    v_add_u32 v58, s6, v87
    buffer_load_dwordx4 v[148:151], v58, s[76:79], 0 offen
    s_cmp_lg_u32 s3, 6
    s_cbranch_scc1 k_pf2
    s_mul_i32 s5, s5, 384
    v_lshlrev_b32 v58, 3, v1
    buffer_load_dwordx2 v[158:159], v58, s[80:83], s5 offen
k_pf2:
    s_lshl_b32 s5, s3, 12
    s_add_u32 m0, s5, 110592
    s_nop 0
    buffer_load_dwordx4 v153, s[72:75], s5 offen offset:0 lds
    buffer_load_dwordx4 v153, s[72:75], s5 offen offset:1024 lds
    buffer_load_dwordx4 v154, s[72:75], s5 offen offset:2048 lds
    buffer_load_dwordx4 v154, s[72:75], s5 offen offset:3072 lds
    s_add_u32 s90, s101, 98
    s_min_u32 s90, s90, 25000
    s_lshl_b32 s30, s90, 10
    s_lshl_b32 s42, s90, 8
    s_lshl_b32 s91, s101, 10
    s_lshl_b32 s90, s3, 10
    s_cmp_lg_u32 s3, 0
    s_cbranch_scc1 sl_1
    s_mov_b32 m0, 57344
    s_add_u32 s97, s91, 98304
    buffer_load_dwordx4 v152, s[28:31], s97 offen lds
sl_1:
    s_add_u32 m0, s90, 32768
    s_nop 0
    buffer_load_dwordx4 v152, s[28:31], s91 offen lds
    s_add_u32 m0, s90, 40960
    s_add_u32 s91, s91, 32768
    buffer_load_dwordx4 v152, s[28:31], s91 offen lds
    s_add_u32 m0, s90, 49152
    s_add_u32 s91, s91, 32768
    buffer_load_dwordx4 v152, s[28:31], s91 offen lds
    s_cmp_lg_u32 s3, 7
    s_cbranch_scc1 k_nodp1
    v_lshlrev_b32 v155, 1, v147
    v_sub_u32 v155, v1, v155
    v_add_u32 v155, s94, v155
    v_mul_u32_u24 v156, 6, v155
    v_and_b32 v156, -4, v156
    buffer_load_dwordx2 v[28:29], v156, s[32:35], 0 offen
    v_lshlrev_b32 v155, 1, v147
    v_sub_u32 v155, v1, v155
    v_add_u32 v155, s94, v155
    v_add_u32 v155, 56, v155
    v_mul_u32_u24 v156, 6, v155
    v_and_b32 v156, -4, v156
    buffer_load_dwordx2 v[30:31], v156, s[32:35], 0 offen
    v_lshlrev_b32 v155, 4, v155
k_nodp1:
    s_mov_b32 s52, s26
    s_mov_b32 s53, s27
    s_mov_b32 s54, 5242880
    s_mov_b32 s55, 0x00020000
    s_mov_b32 s44, s8
    s_mov_b32 s45, s9
    s_mov_b32 s46, 25600000
    s_mov_b32 s47, 0x00020000
    s_mov_b32 s36, s24
    s_mov_b32 s37, s25
    s_mov_b32 s38, 25600000
    s_mov_b32 s39, 0x00020000
    v_min_u32 v58, 143, v0
    v_mov_b32 v59, 162560
    v_lshl_add_u32 v58, v58, 2, v59
    ds_write_b32 v58, v80
    s_mov_b32 s88, 0
    s_mov_b32 s89, 0
    s_mov_b32 s95, 0x00010001
    s_mov_b32 s96, 0x3f803f80
    v_lshrrev_b32 v90, 2, v146
    v_and_b32 v91, 1, v147
    v_lshl_or_b32 v91, v91, 2, v90
    v_lshl_add_u32 v92, v147, 3, v90
    v_and_b32 v93, 3, v146
    v_lshlrev_b32 v93, 3, v93
    s_and_b32 s5, s3, 1
    s_lshl_b32 s6, s5, 2
    v_xor_b32 v94, s6, v91
    v_lshl_add_u32 v94, v94, 5, v93
    v_lshl_add_u32 v94, v92, 8, v94
    v_add_u32 v139, 110592, v94
    v_and_b32 v94, 1, v147
    v_lshlrev_b32 v94, 5, v94
    v_lshrrev_b32 v95, 1, v147
    v_lshl_or_b32 v94, v95, 4, v94
    v_lshl_or_b32 v94, v146, 8, v94
    s_lshl_b32 s5, s5, 7
    v_or_b32 v140, s5, v94
    v_lshl_add_u32 v94, s3, 2, v147
    v_mul_u32_u24 v96, 171, v94
    v_bfe_u32 v97, v96, 9, 2
    v_bfe_u32 v96, v96, 12, 1
    v_lshl_or_b32 v97, v96, 2, v97
    v_lshlrev_b32 v97, 5, v97
    v_xor_b32 v136, v97, v87
    v_add_u32 v94, 32, v94
    v_mul_u32_u24 v96, 171, v94
    v_bfe_u32 v97, v96, 9, 2
    v_bfe_u32 v96, v96, 12, 1
    v_lshl_or_b32 v97, v96, 2, v97
    v_lshlrev_b32 v97, 5, v97
    v_xor_b32 v137, v97, v87
    v_add_u32 v94, 32, v94
    v_mul_u32_u24 v96, 171, v94
    v_bfe_u32 v97, v96, 9, 2
    v_bfe_u32 v96, v96, 12, 1
    v_lshl_or_b32 v97, v96, 2, v97
    v_lshlrev_b32 v97, 5, v97
    v_xor_b32 v138, v97, v87
    v_xor_b32 v94, v147, v146
    v_lshlrev_b32 v94, 4, v94
    v_lshl_or_b32 v94, v146, 8, v94
    s_lshr_b32 s5, s3, 1
    s_lshl_b32 s5, s5, 13
    s_add_u32 s5, s5, 32768
    v_add_u32 v38, s5, v94
    s_cmp_ge_u32 s2, 128
    s_cbranch_scc1 k_noe2
    s_movk_i32 s90, 10700
    s_movk_i32 s91, -98
    s_movk_i32 s97, 147
    s_mov_b32 s6, 143360
    s_mov_b32 s7, 65536
    v_mov_b32 v85, 0
    s_waitcnt vmcnt(10)
    v_mul_u32_u24 v56, s90, v48
    v_lshrrev_b32 v56, 20, v56
    v_lshl_add_u32 v72, v56, 2, s6
    ds_add_rtn_u32 v72, v72, v21
    v_mad_i32_i24 v64, v56, s91, v48
    v_mul_u32_u24 v48, s97, v64
    v_lshrrev_b32 v48, 11, v48
    v_lshl_add_u32 v64, v48, 1, v64
    v_lshl_add_u32 v56, v56, 7, s7
    v_mul_u32_u24 v57, s90, v49
    v_lshrrev_b32 v57, 20, v57
    v_lshl_add_u32 v73, v57, 2, s6
    ds_add_rtn_u32 v73, v73, v21
    v_mad_i32_i24 v65, v57, s91, v49
    v_mul_u32_u24 v49, s97, v65
    v_lshrrev_b32 v49, 11, v49
    v_lshl_add_u32 v65, v49, 1, v65
    v_lshl_add_u32 v57, v57, 7, s7
    v_mul_u32_u24 v58, s90, v50
    v_lshrrev_b32 v58, 20, v58
    v_lshl_add_u32 v74, v58, 2, s6
    ds_add_rtn_u32 v74, v74, v21
    v_mad_i32_i24 v66, v58, s91, v50
    v_mul_u32_u24 v50, s97, v66
    v_lshrrev_b32 v50, 11, v50
    v_lshl_add_u32 v66, v50, 1, v66
    v_lshl_add_u32 v58, v58, 7, s7
    v_mul_u32_u24 v60, s90, v52
    v_lshrrev_b32 v60, 20, v60
    v_lshl_add_u32 v76, v60, 2, s6
    ds_add_rtn_u32 v76, v76, v21
    v_mad_i32_i24 v68, v60, s91, v52
    v_mul_u32_u24 v52, s97, v68
    v_lshrrev_b32 v52, 11, v52
    v_lshl_add_u32 v68, v52, 1, v68
    v_lshl_add_u32 v60, v60, 7, s7
    v_mul_u32_u24 v61, s90, v53
    v_lshrrev_b32 v61, 20, v61
    v_lshl_add_u32 v77, v61, 2, s6
    ds_add_rtn_u32 v77, v77, v21
    v_mad_i32_i24 v69, v61, s91, v53
    v_mul_u32_u24 v53, s97, v69
    v_lshrrev_b32 v53, 11, v53
    v_lshl_add_u32 v69, v53, 1, v69
    v_lshl_add_u32 v61, v61, 7, s7
    v_mul_u32_u24 v62, s90, v54
    v_lshrrev_b32 v62, 20, v62
    v_lshl_add_u32 v78, v62, 2, s6
    ds_add_rtn_u32 v78, v78, v21
    v_mad_i32_i24 v70, v62, s91, v54
    v_mul_u32_u24 v54, s97, v70
    v_lshrrev_b32 v54, 11, v54
    v_lshl_add_u32 v70, v54, 1, v70
    v_lshl_add_u32 v62, v62, 7, s7
    s_waitcnt vmcnt(8)
    s_waitcnt lgkmcnt(5)
    v_and_b32 v48, 7, v72
    v_lshl_add_u32 v56, v48, 4, v56
    v_lshrrev_b32 v48, 3, v72
    v_min_u32 v48, 5, v48
    v_max_u32 v85, v85, v48
    v_add_u32 v56, v56, v48
    ds_write_b8 v56, v64 offset:10
    v_add_u32 v56, v56, v48
    ds_write_b16 v56, v40
    s_waitcnt lgkmcnt(6)
    v_and_b32 v49, 7, v73
    v_lshl_add_u32 v57, v49, 4, v57
    v_lshrrev_b32 v49, 3, v73
    v_min_u32 v49, 5, v49
    v_max_u32 v85, v85, v49
    v_add_u32 v57, v57, v49
    ds_write_b8 v57, v65 offset:10
    v_add_u32 v57, v57, v49
    ds_write_b16 v57, v41
    s_waitcnt lgkmcnt(7)
    v_and_b32 v50, 7, v74
    v_lshl_add_u32 v58, v50, 4, v58
    v_lshrrev_b32 v50, 3, v74
    v_min_u32 v50, 5, v50
    v_max_u32 v85, v85, v50
    v_add_u32 v58, v58, v50
    ds_write_b8 v58, v66 offset:10
    v_add_u32 v58, v58, v50
    ds_write_b16 v58, v42
    s_waitcnt lgkmcnt(8)
    v_and_b32 v52, 7, v76
    v_lshl_add_u32 v60, v52, 4, v60
    v_lshrrev_b32 v52, 3, v76
    v_min_u32 v52, 5, v52
    v_max_u32 v85, v85, v52
    v_add_u32 v60, v60, v52
    ds_write_b8 v60, v68 offset:10
    v_add_u32 v60, v60, v52
    ds_write_b16 v60, v44
    s_waitcnt lgkmcnt(9)
    v_and_b32 v53, 7, v77
    v_lshl_add_u32 v61, v53, 4, v61
    v_lshrrev_b32 v53, 3, v77
    v_min_u32 v53, 5, v53
    v_max_u32 v85, v85, v53
    v_add_u32 v61, v61, v53
    ds_write_b8 v61, v69 offset:10
    v_add_u32 v61, v61, v53
    ds_write_b16 v61, v45
    s_waitcnt lgkmcnt(10)
    v_and_b32 v54, 7, v78
    v_lshl_add_u32 v62, v54, 4, v62
    v_lshrrev_b32 v54, 3, v78
    v_min_u32 v54, 5, v54
    v_max_u32 v85, v85, v54
    v_add_u32 v62, v62, v54
    ds_write_b8 v62, v70 offset:10
    v_add_u32 v62, v62, v54
    ds_write_b16 v62, v46
    s_cmp_lg_u32 s3, 7
    s_cbranch_scc1 k_e1
    s_mov_b32 exec_hi, 2097151
    v_mul_u32_u24 v59, s90, v51
    v_lshrrev_b32 v59, 20, v59
    v_lshl_add_u32 v75, v59, 2, s6
    ds_add_rtn_u32 v75, v75, v21
    v_mad_i32_i24 v67, v59, s91, v51
    v_mul_u32_u24 v51, s97, v67
    v_lshrrev_b32 v51, 11, v51
    v_lshl_add_u32 v67, v51, 1, v67
    v_lshl_add_u32 v59, v59, 7, s7
    s_waitcnt lgkmcnt(0)
    v_and_b32 v51, 7, v75
    v_lshl_add_u32 v59, v51, 4, v59
    v_lshrrev_b32 v51, 3, v75
    v_min_u32 v51, 5, v51
    v_max_u32 v85, v85, v51
    v_add_u32 v59, v59, v51
    ds_write_b8 v59, v67 offset:10
    v_add_u32 v59, v59, v51
    ds_write_b16 v59, v43
    s_mov_b64 exec, -1
k_e1:
    v_cmp_lt_u32 vcc, 4, v85
    s_cbranch_vccz k_noe2
    ds_write_b32 v88, v21 offset:1024
k_noe2:
    s_waitcnt vmcnt(0) lgkmcnt(0)
    s_barrier
    s_cmp_ge_u32 s2, 128
    s_cbranch_scc1 k_noe3
    ds_read_b32 v85, v88 offset:1024
    ds_read_b128 v[40:43], v84 offset:0
    ds_read_b128 v[44:47], v84 offset:8192
    ds_read_b128 v[48:51], v84 offset:16384
    ds_read_b128 v[52:55], v84 offset:24576
    s_lshl_b32 s4, s2, 15
    s_waitcnt lgkmcnt(4)
    v_cmp_ne_u32 vcc, 0, v85
    s_cbranch_vccz k_e2
    v_lshrrev_b32 v86, 3, v0
    v_lshl_add_u32 v86, v86, 2, v88
    v_mov_b32 v82, 0xffff8000
    ds_read_b32 v85, v86 offset:0
    s_waitcnt lgkmcnt(0)
    v_cmp_lt_u32 vcc, 40, v85
    s_nop 1
    v_cndmask_b32 v40, v40, v80, vcc
    v_cndmask_b32 v41, v41, v81, vcc
    v_cndmask_b32 v42, v42, v82, vcc
    v_cndmask_b32 v43, v43, v83, vcc
    ds_read_b32 v85, v86 offset:256
    s_waitcnt lgkmcnt(0)
    v_cmp_lt_u32 vcc, 40, v85
    s_nop 1
    v_cndmask_b32 v44, v44, v80, vcc
    v_cndmask_b32 v45, v45, v81, vcc
    v_cndmask_b32 v46, v46, v82, vcc
    v_cndmask_b32 v47, v47, v83, vcc
    ds_read_b32 v85, v86 offset:512
    s_waitcnt lgkmcnt(0)
    v_cmp_lt_u32 vcc, 40, v85
    s_nop 1
    v_cndmask_b32 v48, v48, v80, vcc
    v_cndmask_b32 v49, v49, v81, vcc
    v_cndmask_b32 v50, v50, v82, vcc
    v_cndmask_b32 v51, v51, v83, vcc
    ds_read_b32 v85, v86 offset:768
    s_waitcnt lgkmcnt(0)
    v_cmp_lt_u32 vcc, 40, v85
    s_nop 1
    v_cndmask_b32 v52, v52, v80, vcc
    v_cndmask_b32 v53, v53, v81, vcc
    v_cndmask_b32 v54, v54, v82, vcc
    v_cndmask_b32 v55, v55, v83, vcc
k_e2:
    buffer_store_dwordx4 v[40:43], v87, s[52:55], s4 offen sc1
    s_add_u32 s4, s4, 8192
    buffer_store_dwordx4 v[44:47], v87, s[52:55], s4 offen sc1
    s_add_u32 s4, s4, 8192
    buffer_store_dwordx4 v[48:51], v87, s[52:55], s4 offen sc1
    s_add_u32 s4, s4, 8192
    buffer_store_dwordx4 v[52:55], v87, s[52:55], s4 offen sc1
k_noe3:
    ds_read_b128 a[56:59], v38 offset:0
    ds_read_b128 a[72:75], v38 offset:4096
    v_xor_b32 v157, 64, v38
    ds_read_b128 a[60:63], v157 offset:0
    ds_read_b128 a[76:79], v157 offset:4096
    v_xor_b32 v158, 128, v38
    ds_read_b128 a[64:67], v158 offset:0
    ds_read_b128 a[80:83], v158 offset:4096
    v_xor_b32 v159, 192, v38
    ds_read_b128 a[68:71], v159 offset:0
    ds_read_b128 a[84:87], v159 offset:4096
    ds_read_b64_tr_b16 v[72:73], v139 offset:0
    ds_read_b64_tr_b16 v[74:75], v139 offset:1024
    ds_read_b64_tr_b16 v[76:77], v139 offset:8192
    ds_read_b64_tr_b16 v[78:79], v139 offset:9216
    ds_read_b64_tr_b16 v[80:81], v139 offset:16384
    ds_read_b64_tr_b16 v[82:83], v139 offset:17408
    ds_read_b64_tr_b16 v[84:85], v139 offset:24576
    ds_read_b64_tr_b16 v[86:87], v139 offset:25600
    v_xor_b32 v157, 32, v139
    ds_read_b64_tr_b16 v[88:89], v157 offset:0
    ds_read_b64_tr_b16 v[90:91], v157 offset:1024
    ds_read_b64_tr_b16 v[92:93], v157 offset:8192
    ds_read_b64_tr_b16 v[94:95], v157 offset:9216
    ds_read_b64_tr_b16 v[96:97], v157 offset:16384
    ds_read_b64_tr_b16 v[98:99], v157 offset:17408
    ds_read_b64_tr_b16 v[100:101], v157 offset:24576
    ds_read_b64_tr_b16 v[102:103], v157 offset:25600
    v_xor_b32 v158, 64, v139
    ds_read_b64_tr_b16 v[104:105], v158 offset:0
    ds_read_b64_tr_b16 v[106:107], v158 offset:1024
    ds_read_b64_tr_b16 v[108:109], v158 offset:8192
    ds_read_b64_tr_b16 v[110:111], v158 offset:9216
    ds_read_b64_tr_b16 v[112:113], v158 offset:16384
    ds_read_b64_tr_b16 v[114:115], v158 offset:17408
    ds_read_b64_tr_b16 v[116:117], v158 offset:24576
    ds_read_b64_tr_b16 v[118:119], v158 offset:25600
    v_xor_b32 v159, 96, v139
    ds_read_b64_tr_b16 v[120:121], v159 offset:0
    ds_read_b64_tr_b16 v[122:123], v159 offset:1024
    ds_read_b64_tr_b16 v[124:125], v159 offset:8192
    ds_read_b64_tr_b16 v[126:127], v159 offset:9216
    ds_read_b64_tr_b16 v[128:129], v159 offset:16384
    ds_read_b64_tr_b16 v[130:131], v159 offset:17408
    ds_read_b64_tr_b16 v[132:133], v159 offset:24576
    ds_read_b64_tr_b16 v[134:135], v159 offset:25600
    s_lshr_b32 s90, s3, 1
    s_lshl_b32 s90, s90, 5
    s_add_u32 s90, s90, s101
    s_lshl_b32 s90, s90, 8
    s_add_u32 s91, s90, 4096
    s_mov_b32 s7, 0xbfb8aa3b
    s_lshl_b32 s5, s3, 10
    s_mov_b32 m0, s5
    s_mov_b32 s6, 0
    buffer_load_dwordx4 v136, s[76:79], s6 offen lds
    s_add_u32 m0, s5, 8192
    s_mov_b32 s6, 8192
    buffer_load_dwordx4 v137, s[76:79], s6 offen lds
    s_add_u32 m0, s5, 16384
    s_mov_b32 s6, 16384
    buffer_load_dwordx4 v138, s[76:79], s6 offen lds
    s_add_u32 m0, s5, 24576
    s_mov_b32 s6, 24576
    buffer_load_dwordx4 v136, s[76:79], s6 offen lds
    s_waitcnt lgkmcnt(15)
    v_mfma_f32_16x16x32_bf16 v[40:43], v[72:75], a[56:59], 0
    v_mfma_f32_16x16x32_bf16 v[56:59], v[72:75], a[72:75], 0
    v_mfma_f32_16x16x32_bf16 v[40:43], v[76:79], a[60:63], v[40:43]
    v_mfma_f32_16x16x32_bf16 v[56:59], v[76:79], a[76:79], v[56:59]
    v_mfma_f32_16x16x32_bf16 v[40:43], v[80:83], a[64:67], v[40:43]
    v_mfma_f32_16x16x32_bf16 v[56:59], v[80:83], a[80:83], v[56:59]
    v_mfma_f32_16x16x32_bf16 v[40:43], v[84:87], a[68:71], v[40:43]
    v_mfma_f32_16x16x32_bf16 v[56:59], v[84:87], a[84:87], v[56:59]
    s_barrier
    v_mfma_f32_16x16x32_bf16 v[44:47], v[88:91], a[56:59], 0
    v_mfma_f32_16x16x32_bf16 v[60:63], v[88:91], a[72:75], 0
    v_mfma_f32_16x16x32_bf16 v[44:47], v[92:95], a[60:63], v[44:47]
    v_mfma_f32_16x16x32_bf16 v[60:63], v[92:95], a[76:79], v[60:63]
    v_mfma_f32_16x16x32_bf16 v[44:47], v[96:99], a[64:67], v[44:47]
    v_mfma_f32_16x16x32_bf16 v[60:63], v[96:99], a[80:83], v[60:63]
    v_mfma_f32_16x16x32_bf16 v[44:47], v[100:103], a[68:71], v[44:47]
    v_mfma_f32_16x16x32_bf16 v[60:63], v[100:103], a[84:87], v[60:63]
    s_add_u32 m0, s5, 65536
    s_mov_b32 s6, 65536
    buffer_load_dwordx4 v138, s[76:79], s6 offen lds
    s_add_u32 m0, s5, 73728
    s_mov_b32 s6, 73728
    buffer_load_dwordx4 v136, s[76:79], s6 offen lds
    s_add_u32 m0, s5, 81920
    s_mov_b32 s6, 81920
    buffer_load_dwordx4 v137, s[76:79], s6 offen lds
    s_waitcnt lgkmcnt(14)
    v_mfma_f32_16x16x32_bf16 v[48:51], v[104:107], a[56:59], 0
    v_mfma_f32_16x16x32_bf16 v[64:67], v[104:107], a[72:75], 0
    s_waitcnt lgkmcnt(12)
    v_mfma_f32_16x16x32_bf16 v[48:51], v[108:111], a[60:63], v[48:51]
    v_mfma_f32_16x16x32_bf16 v[64:67], v[108:111], a[76:79], v[64:67]
    s_waitcnt lgkmcnt(10)
    v_mfma_f32_16x16x32_bf16 v[48:51], v[112:115], a[64:67], v[48:51]
    v_mfma_f32_16x16x32_bf16 v[64:67], v[112:115], a[80:83], v[64:67]
    s_waitcnt lgkmcnt(8)
    v_mfma_f32_16x16x32_bf16 v[48:51], v[116:119], a[68:71], v[48:51]
    v_mfma_f32_16x16x32_bf16 v[64:67], v[116:119], a[84:87], v[64:67]
    s_waitcnt lgkmcnt(6)
    v_mfma_f32_16x16x32_bf16 v[52:55], v[120:123], a[56:59], 0
    v_mfma_f32_16x16x32_bf16 v[68:71], v[120:123], a[72:75], 0
    s_waitcnt lgkmcnt(4)
    v_mfma_f32_16x16x32_bf16 v[52:55], v[124:127], a[60:63], v[52:55]
    v_mfma_f32_16x16x32_bf16 v[68:71], v[124:127], a[76:79], v[68:71]
    s_waitcnt lgkmcnt(2)
    v_mfma_f32_16x16x32_bf16 v[52:55], v[128:131], a[64:67], v[52:55]
    v_mfma_f32_16x16x32_bf16 v[68:71], v[128:131], a[80:83], v[68:71]
    s_waitcnt lgkmcnt(0)
    v_mfma_f32_16x16x32_bf16 v[52:55], v[132:135], a[68:71], v[52:55]
    v_mfma_f32_16x16x32_bf16 v[68:71], v[132:135], a[84:87], v[68:71]
    v_mul_f32 v72, s7, v40
    v_mul_f32 v73, s7, v41
    v_mul_f32 v74, s7, v42
    v_mul_f32 v75, s7, v43
    v_mul_f32 v76, s7, v44
    v_mul_f32 v77, s7, v45
    v_mul_f32 v78, s7, v46
    v_mul_f32 v79, s7, v47
    v_mul_f32 v80, s7, v48
    v_mul_f32 v81, s7, v49
    v_mul_f32 v82, s7, v50
    v_mul_f32 v83, s7, v51
    v_mul_f32 v84, s7, v52
    v_mul_f32 v85, s7, v53
    v_mul_f32 v86, s7, v54
    v_mul_f32 v87, s7, v55
    v_exp_f32 v72, v72
    v_exp_f32 v73, v73
    v_exp_f32 v74, v74
    v_exp_f32 v75, v75
    v_exp_f32 v76, v76
    v_exp_f32 v77, v77
    v_exp_f32 v78, v78
    v_exp_f32 v79, v79
    v_exp_f32 v80, v80
    v_exp_f32 v81, v81
    v_exp_f32 v82, v82
    v_exp_f32 v83, v83
    v_exp_f32 v84, v84
    v_exp_f32 v85, v85
    v_exp_f32 v86, v86
    v_exp_f32 v87, v87
    s_add_u32 m0, s5, 90112
    s_mov_b32 s6, 90112
    buffer_load_dwordx4 v138, s[76:79], s6 offen lds
    s_add_u32 m0, s5, 32768
    s_mov_b32 s6, 32768
    buffer_load_dwordx4 v137, s[76:79], s6 offen lds
    s_add_u32 m0, s5, 40960
    s_mov_b32 s6, 40960
    buffer_load_dwordx4 v138, s[76:79], s6 offen lds
    s_lshl_b32 s6, s3, 11
    s_add_u32 s6, s6, 143872
    v_bfe_u32 v100, v140, 4, 2
    v_and_b32 v101, 7, v146
    v_xor_b32 v100, v100, v101
    v_lshl_add_u32 v100, v146, 3, v100
    v_lshl_add_u32 v100, v100, 4, s6
    v_xor_b32 v103, 64, v100
    v_lshrrev_b32 v101, 3, v1
    v_xor_b32 v102, v101, v1
    v_lshl_add_u32 v102, v102, 4, s6
    v_lshl_add_u32 v101, v101, 7, v2
    v_and_b32 v104, 128, v140
    v_add_u32 v101, v101, v104
    v_add_f32 v72, 1.0, v72
    v_add_f32 v73, 1.0, v73
    v_add_f32 v74, 1.0, v74
    v_add_f32 v75, 1.0, v75
    v_add_f32 v76, 1.0, v76
    v_add_f32 v77, 1.0, v77
    v_add_f32 v78, 1.0, v78
    v_add_f32 v79, 1.0, v79
    v_add_f32 v80, 1.0, v80
    v_add_f32 v81, 1.0, v81
    v_add_f32 v82, 1.0, v82
    v_add_f32 v83, 1.0, v83
    v_add_f32 v84, 1.0, v84
    v_add_f32 v85, 1.0, v85
    v_add_f32 v86, 1.0, v86
    v_add_f32 v87, 1.0, v87
    v_rcp_f32 v72, v72
    v_rcp_f32 v73, v73
    v_rcp_f32 v74, v74
    v_rcp_f32 v75, v75
    v_rcp_f32 v76, v76
    v_rcp_f32 v77, v77
    v_rcp_f32 v78, v78
    v_rcp_f32 v79, v79
    v_rcp_f32 v80, v80
    v_rcp_f32 v81, v81
    v_rcp_f32 v82, v82
    v_rcp_f32 v83, v83
    v_rcp_f32 v84, v84
    v_rcp_f32 v85, v85
    v_rcp_f32 v86, v86
    v_rcp_f32 v87, v87
    s_add_u32 m0, s5, 49152
    s_mov_b32 s6, 49152
    buffer_load_dwordx4 v136, s[76:79], s6 offen lds
    s_add_u32 m0, s5, 57344
    s_mov_b32 s6, 57344
    buffer_load_dwordx4 v137, s[76:79], s6 offen lds
    s_add_u32 m0, s5, 98304
    s_nop 0
    buffer_load_dwordx4 v136, s[80:83], 0 offen lds
    s_cmp_ge_u32 s3, 4
    s_cbranch_scc1 ws_2
    s_add_u32 m0, s5, 106496
    s_movk_i32 s6, 8192
    buffer_load_dwordx4 v137, s[80:83], s6 offen lds
ws_2:
    v_mul_f32 v72, v72, v40
    v_mul_f32 v73, v73, v41
    v_mul_f32 v74, v74, v42
    v_mul_f32 v75, v75, v43
    v_mul_f32 v76, v76, v44
    v_mul_f32 v77, v77, v45
    v_mul_f32 v78, v78, v46
    v_mul_f32 v79, v79, v47
    v_mul_f32 v80, v80, v48
    v_mul_f32 v81, v81, v49
    v_mul_f32 v82, v82, v50
    v_mul_f32 v83, v83, v51
    v_mul_f32 v84, v84, v52
    v_mul_f32 v85, v85, v53
    v_mul_f32 v86, v86, v54
    v_mul_f32 v87, v87, v55
    v_cvt_pk_bf16_f32 v40, v72, v73
    v_cvt_pk_bf16_f32 v41, v74, v75
    v_cvt_pk_bf16_f32 v42, v76, v77
    v_cvt_pk_bf16_f32 v43, v78, v79
    v_cvt_pk_bf16_f32 v44, v80, v81
    v_cvt_pk_bf16_f32 v45, v82, v83
    v_cvt_pk_bf16_f32 v46, v84, v85
    v_cvt_pk_bf16_f32 v47, v86, v87
    v_permlane16_swap_b32 v40, v42
    v_permlane16_swap_b32 v41, v43
    v_permlane16_swap_b32 v44, v46
    v_permlane16_swap_b32 v45, v47
    ds_write_b128 v100, v[40:43]
    ds_write_b128 v103, v[44:47]
    ds_read_b128 v[48:51], v102 offset:0
    ds_read_b128 v[52:55], v102 offset:1024
    s_waitcnt lgkmcnt(1)
    buffer_store_dwordx4 v[48:51], v101, s[40:43], s90 offen offset:0 sc1
    s_waitcnt lgkmcnt(0)
    buffer_store_dwordx4 v[52:55], v101, s[40:43], s90 offen offset:2048 sc1
    s_cmp_ge_u32 s3, 6
    s_cbranch_scc1 n1_3
    v_mul_f32 v72, s7, v56
    v_mul_f32 v73, s7, v57
    v_mul_f32 v74, s7, v58
    v_mul_f32 v75, s7, v59
    v_mul_f32 v76, s7, v60
    v_mul_f32 v77, s7, v61
    v_mul_f32 v78, s7, v62
    v_mul_f32 v79, s7, v63
    v_mul_f32 v80, s7, v64
    v_mul_f32 v81, s7, v65
    v_mul_f32 v82, s7, v66
    v_mul_f32 v83, s7, v67
    v_mul_f32 v84, s7, v68
    v_mul_f32 v85, s7, v69
    v_mul_f32 v86, s7, v70
    v_mul_f32 v87, s7, v71
    v_exp_f32 v72, v72
    v_exp_f32 v73, v73
    v_exp_f32 v74, v74
    v_exp_f32 v75, v75
    v_exp_f32 v76, v76
    v_exp_f32 v77, v77
    v_exp_f32 v78, v78
    v_exp_f32 v79, v79
    v_exp_f32 v80, v80
    v_exp_f32 v81, v81
    v_exp_f32 v82, v82
    v_exp_f32 v83, v83
    v_exp_f32 v84, v84
    v_exp_f32 v85, v85
    v_exp_f32 v86, v86
    v_exp_f32 v87, v87
    v_add_f32 v72, 1.0, v72
    v_add_f32 v73, 1.0, v73
    v_add_f32 v74, 1.0, v74
    v_add_f32 v75, 1.0, v75
    v_add_f32 v76, 1.0, v76
    v_add_f32 v77, 1.0, v77
    v_add_f32 v78, 1.0, v78
    v_add_f32 v79, 1.0, v79
    v_add_f32 v80, 1.0, v80
    v_add_f32 v81, 1.0, v81
    v_add_f32 v82, 1.0, v82
    v_add_f32 v83, 1.0, v83
    v_add_f32 v84, 1.0, v84
    v_add_f32 v85, 1.0, v85
    v_add_f32 v86, 1.0, v86
    v_add_f32 v87, 1.0, v87
    v_rcp_f32 v72, v72
    v_rcp_f32 v73, v73
    v_rcp_f32 v74, v74
    v_rcp_f32 v75, v75
    v_rcp_f32 v76, v76
    v_rcp_f32 v77, v77
    v_rcp_f32 v78, v78
    v_rcp_f32 v79, v79
    v_rcp_f32 v80, v80
    v_rcp_f32 v81, v81
    v_rcp_f32 v82, v82
    v_rcp_f32 v83, v83
    v_rcp_f32 v84, v84
    v_rcp_f32 v85, v85
    v_rcp_f32 v86, v86
    v_rcp_f32 v87, v87
    v_mul_f32 v72, v72, v56
    v_mul_f32 v73, v73, v57
    v_mul_f32 v74, v74, v58
    v_mul_f32 v75, v75, v59
    v_mul_f32 v76, v76, v60
    v_mul_f32 v77, v77, v61
    v_mul_f32 v78, v78, v62
    v_mul_f32 v79, v79, v63
    v_mul_f32 v80, v80, v64
    v_mul_f32 v81, v81, v65
    v_mul_f32 v82, v82, v66
    v_mul_f32 v83, v83, v67
    v_mul_f32 v84, v84, v68
    v_mul_f32 v85, v85, v69
    v_mul_f32 v86, v86, v70
    v_mul_f32 v87, v87, v71
    v_cvt_pk_bf16_f32 v56, v72, v73
    v_cvt_pk_bf16_f32 v57, v74, v75
    v_cvt_pk_bf16_f32 v58, v76, v77
    v_cvt_pk_bf16_f32 v59, v78, v79
    v_cvt_pk_bf16_f32 v60, v80, v81
    v_cvt_pk_bf16_f32 v61, v82, v83
    v_cvt_pk_bf16_f32 v62, v84, v85
    v_cvt_pk_bf16_f32 v63, v86, v87
    v_permlane16_swap_b32 v56, v58
    v_permlane16_swap_b32 v57, v59
    v_permlane16_swap_b32 v60, v62
    v_permlane16_swap_b32 v61, v63
    ds_write_b128 v100, v[56:59]
    ds_write_b128 v103, v[60:63]
    ds_read_b128 v[64:67], v102 offset:0
    ds_read_b128 v[68:71], v102 offset:1024
    s_waitcnt lgkmcnt(1)
    buffer_store_dwordx4 v[64:67], v101, s[40:43], s91 offen offset:0 sc1
    s_waitcnt lgkmcnt(0)
    buffer_store_dwordx4 v[68:71], v101, s[40:43], s91 offen offset:2048 sc1
n1_3:
    s_mov_b32 s30, 25600000
    s_mov_b32 s42, 6400000
    v_lshrrev_b32 v144, 3, v0
    v_lshlrev_b32 v144, 15, v144
    v_and_b32 v90, 7, v0
    v_lshl_or_b32 v144, v90, 4, v144
    s_lshl_b32 s4, s2, 7
    s_add_u32 s5, s4, 2097152
    buffer_load_dwordx4 v[40:43], v144, s[52:55], s4 offen sc1
    buffer_load_dwordx4 v[44:47], v144, s[52:55], s5 offen sc1
    s_cmp_lg_u32 s3, 7
    s_cbranch_scc1 k_nodp2
    v_mov_b32 v90, 160464
    v_add_u32 v91, v90, v2
    v_alignbit_b32 v93, v29, v28, v155
    v_lshrrev_b32 v94, v155, v29
    v_lshlrev_b32 v92, 16, v93
    v_and_b32 v93, 0xffff0000, v93
    v_lshlrev_b32 v94, 16, v94
    v_mov_b32 v95, 162560
    v_lshl_add_u32 v95, v147, 2, v95
    ds_write_b128 v91, v[92:95] offset:0
    v_alignbit_b32 v93, v31, v30, v155
    v_lshrrev_b32 v94, v155, v31
    v_lshlrev_b32 v92, 16, v93
    v_and_b32 v93, 0xffff0000, v93
    v_lshlrev_b32 v94, 16, v94
    v_mov_b32 v95, 162576
    v_lshl_add_u32 v95, v147, 2, v95
    ds_write_b128 v91, v[92:95] offset:1024
    v_mov_b32 v92, 0x5d5e0b6b
    v_mov_b32 v93, 0x5d5e0b6b
    v_mov_b32 v94, 0x5d5e0b6b
    v_add_u32 v90, -16, v90
    ds_write_b128 v90, v[92:95]
k_nodp2:
    s_mov_b32 s84, 0x3fff3fff
    s_mov_b32 s85, 0x3fff3fff
    s_xor_b32 s93, s3, 4
    s_lshl_b32 s93, s93, 1
    s_lshl_b32 s98, s94, 10
    v_lshrrev_b32 v90, 2, v146
    v_and_b32 v91, 1, v147
    v_lshl_or_b32 v91, v91, 2, v90
    v_xor_b32 v91, s3, v91
    v_lshl_add_u32 v91, v91, 5, v145
    v_lshl_add_u32 v92, v147, 3, v90
    s_movk_i32 s6, 768
    v_mad_u32_u24 v141, v92, s6, v91
    v_add_u32 v142, 49152, v141
    v_lshrrev_b32 v91, 1, v147
    v_lshl_or_b32 v91, v91, 2, v90
    v_xor_b32 v91, s3, v91
    v_lshl_add_u32 v91, v91, 5, v145
    v_lshl_add_u32 v92, v147, 2, v90
    v_mad_u32_u24 v143, v92, s6, v91
    v_add_u32 v143, 98304, v143
    v_lshlrev_b32 v93, 1, v147
    v_xor_b32 v93, v93, v146
    s_and_b32 s6, s3, 1
    s_lshl_b32 s6, s6, 3
    s_add_u32 s6, s6, 16
    v_xor_b32 v93, s6, v93
    v_lshlrev_b32 v3, 4, v93
    s_and_b32 s6, s3, 3
    s_lshl_b32 s6, s6, 2
    v_xor_b32 v95, v147, v146
    v_xor_b32 v93, s6, v95
    v_lshlrev_b32 v4, 4, v93
    s_lshl_b32 s6, s3, 4
    s_add_u32 s7, s6, 152000
    v_lshl_add_u32 v36, v147, 2, s7
    v_lshlrev_b32 v92, 5, v145
    v_lshl_add_u32 v92, v90, 12, v92
    v_lshl_add_u32 v92, v95, 4, v92
    v_add_u32 v8, 3072, v92
    v_xor_b32 v9, 64, v8
    v_xor_b32 v10, 128, v8
    v_xor_b32 v11, 192, v8
    v_and_b32 v91, 1, v147
    v_lshl_or_b32 v91, v91, 2, v90
    v_xor_b32 v91, s3, v91
    v_lshl_add_u32 v91, v91, 5, v145
    v_lshl_add_u32 v91, v90, 8, v91
    v_lshl_add_u32 v12, v147, 12, v91
    v_add_u32 v34, 126400, v2
    v_lshlrev_b32 v35, 4, v147
    v_add_u32 v35, 143680, v35
    v_lshl_or_b32 v37, v146, 16, v146
    v_lshrrev_b32 v91, 1, v147
    v_lshl_add_u32 v91, s3, 1, v91
    v_xor_b32 v91, v91, v146
    v_lshl_add_u32 v91, v146, 6, v91
    v_and_b32 v92, 1, v147
    v_lshl_add_u32 v91, v91, 1, v92
    v_mov_b32 v92, 98304
    v_lshl_add_u32 v24, v91, 3, v92
    v_xor_b32 v91, s3, v1
    v_lshl_add_u32 v91, s3, 6, v91
    v_lshlrev_b32 v6, 4, v91
    s_mul_i32 s6, s3, 48
    s_add_u32 s6, s6, 512
    v_add_u32 v91, s6, v1
    v_lshrrev_b32 v92, 6, v91
    v_xor_b32 v91, v91, v92
    v_lshlrev_b32 v7, 4, v91
    s_lshl_b32 s92, s6, 4
    s_add_u32 s92, s92, 98304
    v_xor_b32 v91, 256, v0
    v_mov_b32 v92, 143808
    v_lshl_add_u32 v25, v91, 2, v92
    v_lshrrev_b32 v93, 5, v91
    v_bfe_u32 v94, v0, 4, 1
    v_lshl_add_u32 v92, v93, 7, v92
    v_lshl_add_u32 v92, v94, 3, v92
    v_and_b32 v95, 3, v0
    v_lshl_add_u32 v92, v95, 1, v92
    v_lshl_add_u32 v92, v90, 4, v92
    v_add_u32 v26, 6144, v92
    v_lshlrev_b32 v27, 10, v93
    v_lshl_add_u32 v27, v146, 4, v27
    v_lshl_add_u32 v27, v94, 3, v27
    v_add_u32 v27, 127424, v27
    v_lshlrev_b32 v91, 2, v147
    v_sub_u32 v91, v146, v91
    v_add_u32 v91, 16, v91
    v_lshl_or_b32 v91, v91, 16, v91
    v_xor_b32 v92, 1114128, v91
    v_pk_sub_u16 v92, s95, v92 clamp
    v_pk_mul_lo_u16 v92, s96, v92
    v_accvgpr_write_b32 a92, v92
    v_xor_b32 v92, 1245202, v91
    v_pk_sub_u16 v92, s95, v92 clamp
    v_pk_mul_lo_u16 v92, s96, v92
    v_accvgpr_write_b32 a93, v92
    s_mov_b32 s97, 0x80008000
    s_mov_b32 s90, 0x0000000c
    s_memrealtime s[6:7]
    s_waitcnt vmcnt(0) lgkmcnt(0)
    s_barrier
    s_cmp_lg_u32 s3, 7
    s_cbranch_scc1 k_poll
    v_mov_b32 v90, s99
    v_lshlrev_b32 v91, 12, v1
    s_lshl_b32 s8, s2, 2
    s_add_u32 s8, s8, 4194304
    s_mov_b64 exec, 65535
    buffer_store_dword v90, v91, s[52:55], s8 offen sc1
    s_mov_b64 exec, -1
k_poll:
    s_lshr_b64 s[6:7], s[6:7], 6
    s_sub_u32 s6, s6, s100
    s_add_u32 s7, s6, 3
    v_lshrrev_b32 v90, 24, v43
    v_lshlrev_b32 v90, v145, v90
    v_or_b32 v91, v40, v41
    v_lshrrev_b32 v92, 24, v47
    v_lshlrev_b32 v92, v145, v92
    v_or_b32 v93, v44, v45
    v_or_b32_dpp v90, v90, v90 quad_perm:[1,0,3,2] row_mask:0xf bank_mask:0xf
    v_or_b32_dpp v92, v92, v92 quad_perm:[1,0,3,2] row_mask:0xf bank_mask:0xf
    s_nop 0
    v_or_b32_dpp v90, v90, v90 quad_perm:[2,3,0,1] row_mask:0xf bank_mask:0xf
    v_or_b32_dpp v92, v92, v92 quad_perm:[2,3,0,1] row_mask:0xf bank_mask:0xf
    v_perm_b32 v94, v90, v90, s90
    v_xor_b32 v90, v90, v94
    v_subrev_u32 v90, s100, v90
    v_and_or_b32 v90, v91, s97, v90
    v_cmp_le_u32 s[64:65], s7, v90
    v_perm_b32 v95, v92, v92, s90
    v_xor_b32 v92, v92, v95
    v_subrev_u32 v92, s100, v92
    v_and_or_b32 v92, v93, s97, v92
    v_cmp_le_u32 s[66:67], s7, v92
    s_or_b64 vcc, s[64:65], s[66:67]
    s_cbranch_scc0 k_polled
    s_cmp_gt_u32 s6, 400
    s_cbranch_scc1 k_ptmo
    s_sleep 4
    s_mov_b64 exec, s[64:65]
    s_cbranch_execz pj_4
    buffer_load_dwordx4 v[40:43], v144, s[52:55], s4 offen sc1
pj_4:
    s_mov_b64 exec, s[66:67]
    s_cbranch_execz pj_5
    buffer_load_dwordx4 v[44:47], v144, s[52:55], s5 offen sc1
pj_5:
    s_mov_b64 exec, -1
    s_memrealtime s[6:7]
    s_waitcnt vmcnt(0) lgkmcnt(0)
    s_branch k_poll
k_ptmo:
    v_mov_b32 v40, 0
    v_mov_b32 v41, 0
    v_mov_b32 v42, 0xffff0000
    v_mov_b32 v43, -1
    v_mov_b32 v44, 0
    v_mov_b32 v45, 0
    v_mov_b32 v46, 0xffff0000
    v_mov_b32 v47, -1
    v_mov_b32 v90, 162560
    ds_write_b32 v90, v21 offset:36
k_polled:
    s_mov_b32 s6, 160464
    s_mov_b32 s21, 2
    v_bfe_i32 v55, v42, 16, 8
    v_bfe_i32 v63, v46, 16, 8
    v_and_b32 v54, 0xffff, v40
    v_mul_u32_u24 v52, 6, v54
    v_and_b32 v52, -4, v52
    buffer_load_dwordx2 v[52:53], v52, s[32:35], 0 offen
    v_lshl_add_u32 v48, v55, 4, s6
    ds_read_b128 v[48:51], v48
    v_lshl_or_b32 v54, v55, 24, v54
    v_and_b32 v62, 0xffff, v44
    v_mul_u32_u24 v60, 6, v62
    v_and_b32 v60, -4, v60
    buffer_load_dwordx2 v[60:61], v60, s[32:35], 0 offen
    v_lshl_add_u32 v56, v63, 4, s6
    ds_read_b128 v[56:59], v56
    v_lshl_or_b32 v62, v63, 24, v62
    v_bfe_i32 v71, v42, 24, 8
    v_bfe_i32 v79, v46, 24, 8
    v_lshrrev_b32 v70, 16, v40
    v_mul_u32_u24 v68, 6, v70
    v_and_b32 v68, -4, v68
    buffer_load_dwordx2 v[68:69], v68, s[32:35], 0 offen
    v_lshl_add_u32 v64, v71, 4, s6
    ds_read_b128 v[64:67], v64
    v_lshl_or_b32 v70, v71, 24, v70
    v_lshrrev_b32 v78, 16, v44
    v_mul_u32_u24 v76, 6, v78
    v_and_b32 v76, -4, v76
    buffer_load_dwordx2 v[76:77], v76, s[32:35], 0 offen
    v_lshl_add_u32 v72, v79, 4, s6
    ds_read_b128 v[72:75], v72
    v_lshl_or_b32 v78, v79, 24, v78
    v_bfe_i32 v87, v43, 0, 8
    v_bfe_i32 v95, v47, 0, 8
    v_and_b32 v28, v87, v95
    v_cmp_le_i32 vcc, 0, v28
    s_cbranch_vccz k_g1
    s_mov_b32 s21, 3
    v_and_b32 v86, 0xffff, v41
    v_mul_u32_u24 v84, 6, v86
    v_and_b32 v84, -4, v84
    buffer_load_dwordx2 v[84:85], v84, s[32:35], 0 offen
    v_lshl_add_u32 v80, v87, 4, s6
    ds_read_b128 v[80:83], v80
    v_lshl_or_b32 v86, v87, 24, v86
    v_and_b32 v94, 0xffff, v45
    v_mul_u32_u24 v92, 6, v94
    v_and_b32 v92, -4, v92
    buffer_load_dwordx2 v[92:93], v92, s[32:35], 0 offen
    v_lshl_add_u32 v88, v95, 4, s6
    ds_read_b128 v[88:91], v88
    v_lshl_or_b32 v94, v95, 24, v94
    v_bfe_i32 v103, v43, 8, 8
    v_bfe_i32 v111, v47, 8, 8
    v_and_b32 v28, v103, v111
    v_cmp_le_i32 vcc, 0, v28
    s_cbranch_vccz k_g1
    s_mov_b32 s21, 4
    v_lshrrev_b32 v102, 16, v41
    v_mul_u32_u24 v100, 6, v102
    v_and_b32 v100, -4, v100
    buffer_load_dwordx2 v[100:101], v100, s[32:35], 0 offen
    v_lshl_add_u32 v96, v103, 4, s6
    ds_read_b128 v[96:99], v96
    v_lshl_or_b32 v102, v103, 24, v102
    v_lshrrev_b32 v110, 16, v45
    v_mul_u32_u24 v108, 6, v110
    v_and_b32 v108, -4, v108
    buffer_load_dwordx2 v[108:109], v108, s[32:35], 0 offen
    v_lshl_add_u32 v104, v111, 4, s6
    ds_read_b128 v[104:107], v104
    v_lshl_or_b32 v110, v111, 24, v110
    v_bfe_i32 v119, v43, 16, 8
    v_bfe_i32 v127, v47, 16, 8
    v_and_b32 v28, v119, v127
    v_cmp_le_i32 vcc, 0, v28
    s_cbranch_vccz k_g1
    s_mov_b32 s21, 5
    v_and_b32 v118, 0x7fff, v42
    v_mul_u32_u24 v116, 6, v118
    v_and_b32 v116, -4, v116
    buffer_load_dwordx2 v[116:117], v116, s[32:35], 0 offen
    v_lshl_add_u32 v112, v119, 4, s6
    ds_read_b128 v[112:115], v112
    v_lshl_or_b32 v118, v119, 24, v118
    v_and_b32 v126, 0x7fff, v46
    v_mul_u32_u24 v124, 6, v126
    v_and_b32 v124, -4, v124
    buffer_load_dwordx2 v[124:125], v124, s[32:35], 0 offen
    v_lshl_add_u32 v120, v127, 4, s6
    ds_read_b128 v[120:123], v120
    v_lshl_or_b32 v126, v127, 24, v126
k_g1:
    v_or_b32 v28, v42, v46
    v_and_b32 v28, 0x8000, v28
    v_cmp_ne_u32 vcc, 0, v28
    s_cbranch_vccz k_g2
    v_mov_b32 v29, 162560
    ds_write_b32 v29, v21 offset:32
    v_lshrrev_b32 v28, 3, v0
    v_lshl_add_u32 v29, v28, 2, v29
    v_bfe_u32 v28, v42, 15, 1
    ds_write_b32 v29, v28 offset:64
    v_bfe_u32 v28, v46, 15, 1
    ds_write_b32 v29, v28 offset:320
k_g2:
    s_and_b32 s8, s2, 15
    s_lshl_b32 s8, s8, 12
    s_add_u32 s8, s8, 4194304
    s_cmp_lg_u32 s3, 7
    s_cbranch_scc1 k_g3
    buffer_load_dwordx4 v[40:43], v2, s[52:55], s8 offen sc1
k_g3:
    ds_read_b64_tr_b16 a[48:49], v143 offset:0
    ds_read_b64_tr_b16 a[50:51], v143 offset:256
    ds_read_b64_tr_b16 a[52:53], v143 offset:512
    ds_read_b64_tr_b16 a[32:33], v141 offset:512
    ds_read_b64_tr_b16 a[34:35], v141 offset:3584
    ds_read_b64_tr_b16 a[36:37], v141 offset:25088
    ds_read_b64_tr_b16 a[38:39], v141 offset:28160
    ds_read_b64_tr_b16 a[40:41], v142 offset:512
    ds_read_b64_tr_b16 a[42:43], v142 offset:3584
    ds_read_b64_tr_b16 a[44:45], v142 offset:25088
    ds_read_b64_tr_b16 a[46:47], v142 offset:28160
    ds_read_b64_tr_b16 a[16:17], v141 offset:256
    ds_read_b64_tr_b16 a[18:19], v141 offset:3328
    ds_read_b64_tr_b16 a[20:21], v141 offset:24832
    ds_read_b64_tr_b16 a[22:23], v141 offset:27904
    ds_read_b64_tr_b16 a[24:25], v142 offset:256
    ds_read_b64_tr_b16 a[26:27], v142 offset:3328
    ds_read_b64_tr_b16 a[28:29], v142 offset:24832
    ds_read_b64_tr_b16 a[30:31], v142 offset:27904
    ds_read_b64_tr_b16 a[0:1], v141 offset:0
    ds_read_b64_tr_b16 a[2:3], v141 offset:3072
    ds_read_b64_tr_b16 a[4:5], v141 offset:24576
    ds_read_b64_tr_b16 a[6:7], v141 offset:27648
    ds_read_b64_tr_b16 a[8:9], v142 offset:0
    ds_read_b64_tr_b16 a[10:11], v142 offset:3072
    ds_read_b64_tr_b16 a[12:13], v142 offset:24576
    ds_read_b64_tr_b16 a[14:15], v142 offset:27648
    s_mov_b32 s6, 0x41c0cccd
    s_cmp_eq_u32 s3, 7
    s_cbranch_scc1 k_g4
    s_waitcnt vmcnt(0)
k_g4:
    s_waitcnt vmcnt(1) lgkmcnt(0)
    s_cmp_ge_u32 s3, 7
    s_cbranch_scc1 pf_6
    v_lshlrev_b32 v28, 7, v0
    s_lshl_b32 s7, s94, 10
    buffer_load_dword a54, v28, s[28:31], s7 offen
pf_6:
    v_lshlrev_b32 v55, 4, v54
    v_alignbit_b32 v52, v53, v52, v55
    v_lshrrev_b32 v53, v55, v53
    v_lshlrev_b32 v55, 16, v52
    v_and_b32 v52, 0xffff0000, v52
    v_lshlrev_b32 v53, 16, v53
    v_sub_f32 v48, v55, v48
    v_sub_f32 v49, v52, v49
    v_sub_f32 v50, v53, v50
    v_mul_f32 v55, v48, v48
    v_fmac_f32 v55, v49, v49
    v_fmac_f32 v55, v50, v50
    v_cmp_gt_f32 s[64:65], s6, v55
    s_mov_b64 exec, s[64:65]
    ds_add_rtn_u32 v52, v51, v21
    s_mov_b64 exec, -1
    v_lshlrev_b32 v63, 4, v62
    v_alignbit_b32 v60, v61, v60, v63
    v_lshrrev_b32 v61, v63, v61
    v_lshlrev_b32 v63, 16, v60
    v_and_b32 v60, 0xffff0000, v60
    v_lshlrev_b32 v61, 16, v61
    v_sub_f32 v56, v63, v56
    v_sub_f32 v57, v60, v57
    v_sub_f32 v58, v61, v58
    v_mul_f32 v63, v56, v56
    v_fmac_f32 v63, v57, v57
    v_fmac_f32 v63, v58, v58
    v_cmp_gt_f32 s[66:67], s6, v63
    s_mov_b64 exec, s[66:67]
    ds_add_rtn_u32 v60, v59, v21
    s_mov_b64 exec, -1
    v_lshlrev_b32 v71, 4, v70
    v_alignbit_b32 v68, v69, v68, v71
    v_lshrrev_b32 v69, v71, v69
    v_lshlrev_b32 v71, 16, v68
    v_and_b32 v68, 0xffff0000, v68
    v_lshlrev_b32 v69, 16, v69
    v_sub_f32 v64, v71, v64
    v_sub_f32 v65, v68, v65
    v_sub_f32 v66, v69, v66
    v_mul_f32 v71, v64, v64
    v_fmac_f32 v71, v65, v65
    v_fmac_f32 v71, v66, v66
    v_cmp_gt_f32 s[68:69], s6, v71
    s_mov_b64 exec, s[68:69]
    ds_add_rtn_u32 v68, v67, v21
    s_mov_b64 exec, -1
    v_lshlrev_b32 v79, 4, v78
    v_alignbit_b32 v76, v77, v76, v79
    v_lshrrev_b32 v77, v79, v77
    v_lshlrev_b32 v79, 16, v76
    v_and_b32 v76, 0xffff0000, v76
    v_lshlrev_b32 v77, 16, v77
    v_sub_f32 v72, v79, v72
    v_sub_f32 v73, v76, v73
    v_sub_f32 v74, v77, v74
    v_mul_f32 v79, v72, v72
    v_fmac_f32 v79, v73, v73
    v_fmac_f32 v79, v74, v74
    v_cmp_gt_f32 s[70:71], s6, v79
    s_mov_b64 exec, s[70:71]
    ds_add_rtn_u32 v76, v75, v21
    s_mov_b64 exec, -1
    s_cmp_le_u32 s21, 2
    s_cbranch_scc1 k_bin
    v_lshlrev_b32 v87, 4, v86
    v_alignbit_b32 v84, v85, v84, v87
    v_lshrrev_b32 v85, v87, v85
    v_lshlrev_b32 v87, 16, v84
    v_and_b32 v84, 0xffff0000, v84
    v_lshlrev_b32 v85, 16, v85
    v_sub_f32 v80, v87, v80
    v_sub_f32 v81, v84, v81
    v_sub_f32 v82, v85, v82
    v_mul_f32 v87, v80, v80
    v_fmac_f32 v87, v81, v81
    v_fmac_f32 v87, v82, v82
    v_cmp_gt_f32 s[72:73], s6, v87
    s_mov_b64 exec, s[72:73]
    ds_add_rtn_u32 v84, v83, v21
    s_mov_b64 exec, -1
    v_lshlrev_b32 v95, 4, v94
    v_alignbit_b32 v92, v93, v92, v95
    v_lshrrev_b32 v93, v95, v93
    v_lshlrev_b32 v95, 16, v92
    v_and_b32 v92, 0xffff0000, v92
    v_lshlrev_b32 v93, 16, v93
    v_sub_f32 v88, v95, v88
    v_sub_f32 v89, v92, v89
    v_sub_f32 v90, v93, v90
    v_mul_f32 v95, v88, v88
    v_fmac_f32 v95, v89, v89
    v_fmac_f32 v95, v90, v90
    v_cmp_gt_f32 s[74:75], s6, v95
    s_mov_b64 exec, s[74:75]
    ds_add_rtn_u32 v92, v91, v21
    s_mov_b64 exec, -1
    s_cmp_le_u32 s21, 3
    s_cbranch_scc1 k_bin
    v_lshlrev_b32 v103, 4, v102
    v_alignbit_b32 v100, v101, v100, v103
    v_lshrrev_b32 v101, v103, v101
    v_lshlrev_b32 v103, 16, v100
    v_and_b32 v100, 0xffff0000, v100
    v_lshlrev_b32 v101, 16, v101
    v_sub_f32 v96, v103, v96
    v_sub_f32 v97, v100, v97
    v_sub_f32 v98, v101, v98
    v_mul_f32 v103, v96, v96
    v_fmac_f32 v103, v97, v97
    v_fmac_f32 v103, v98, v98
    v_cmp_gt_f32 s[76:77], s6, v103
    s_mov_b64 exec, s[76:77]
    ds_add_rtn_u32 v100, v99, v21
    s_mov_b64 exec, -1
    v_lshlrev_b32 v111, 4, v110
    v_alignbit_b32 v108, v109, v108, v111
    v_lshrrev_b32 v109, v111, v109
    v_lshlrev_b32 v111, 16, v108
    v_and_b32 v108, 0xffff0000, v108
    v_lshlrev_b32 v109, 16, v109
    v_sub_f32 v104, v111, v104
    v_sub_f32 v105, v108, v105
    v_sub_f32 v106, v109, v106
    v_mul_f32 v111, v104, v104
    v_fmac_f32 v111, v105, v105
    v_fmac_f32 v111, v106, v106
    v_cmp_gt_f32 s[78:79], s6, v111
    s_mov_b64 exec, s[78:79]
    ds_add_rtn_u32 v108, v107, v21
    s_mov_b64 exec, -1
    s_cmp_le_u32 s21, 4
    s_cbranch_scc1 k_bin
    v_lshlrev_b32 v119, 4, v118
    v_alignbit_b32 v116, v117, v116, v119
    v_lshrrev_b32 v117, v119, v117
    v_lshlrev_b32 v119, 16, v116
    v_and_b32 v116, 0xffff0000, v116
    v_lshlrev_b32 v117, 16, v117
    v_sub_f32 v112, v119, v112
    v_sub_f32 v113, v116, v113
    v_sub_f32 v114, v117, v114
    v_mul_f32 v119, v112, v112
    v_fmac_f32 v119, v113, v113
    v_fmac_f32 v119, v114, v114
    v_cmp_gt_f32 s[80:81], s6, v119
    s_mov_b64 exec, s[80:81]
    ds_add_rtn_u32 v116, v115, v21
    s_mov_b64 exec, -1
    v_lshlrev_b32 v127, 4, v126
    v_alignbit_b32 v124, v125, v124, v127
    v_lshrrev_b32 v125, v127, v125
    v_lshlrev_b32 v127, 16, v124
    v_and_b32 v124, 0xffff0000, v124
    v_lshlrev_b32 v125, 16, v125
    v_sub_f32 v120, v127, v120
    v_sub_f32 v121, v124, v121
    v_sub_f32 v122, v125, v122
    v_mul_f32 v127, v120, v120
    v_fmac_f32 v127, v121, v121
    v_fmac_f32 v127, v122, v122
    v_cmp_gt_f32 s[82:83], s6, v127
    s_mov_b64 exec, s[82:83]
    ds_add_rtn_u32 v124, v123, v21
    s_mov_b64 exec, -1
k_bin:
    s_mov_b32 s90, 162560
    v_and_b32 v28, 15, v1
    v_lshl_add_u32 v29, v28, 2, s90
    s_waitcnt lgkmcnt(0)
    s_barrier
    ds_read_b32 v28, v29
    s_waitcnt lgkmcnt(0)
    v_add_u32_dpp v22, v28, v28 row_shr:1 row_mask:0xf bank_mask:0xf bound_ctrl:0
    v_readlane_b32 s90, v28, 8
    s_nop 0
    v_add_u32_dpp v22, v22, v22 row_shr:2 row_mask:0xf bank_mask:0xf bound_ctrl:0
    v_readlane_b32 s97, v28, 9
    s_nop 0
    v_add_u32_dpp v22, v22, v22 row_shr:4 row_mask:0xf bank_mask:0xf bound_ctrl:0
    s_or_b32 s88, s88, s90
    v_sub_u32 v30, v22, v28
    v_add_u32 v30, 35952, v30
    ds_bpermute_b32 v53, v51, v30
    ds_bpermute_b32 v61, v59, v30
    ds_bpermute_b32 v69, v67, v30
    ds_bpermute_b32 v77, v75, v30
    v_readlane_b32 s91, v22, 6
    s_cmp_eq_u32 s89, 0
    s_cbranch_scc1 k_main
    s_mov_b64 s[18:19], 0
    s_cmp_eq_u32 s91, 0
    s_cbranch_scc1 k_ovf_next
    s_waitcnt vmcnt(0)
    buffer_inv sc1
    s_branch k_place
k_all:
    v_and_b32 v28, 127, v0
    v_mov_b32 v29, 162624
    v_lshl_add_u32 v29, v28, 2, v29
    ds_write_b32 v29, v21
    s_mov_b32 s88, 1
    s_mov_b32 s91, 0
    v_mov_b32 v22, 0
    s_mov_b32 s21, 0
    s_branch k_place
k_main:
    s_cmp_le_u32 s91, 448
    s_cselect_b64 s[18:19], -1, 0
    s_cmp_gt_u32 s91, 2048
    s_cselect_b32 s97, 1, s97
    s_cmp_lg_u32 s97, 0
    s_cbranch_scc1 k_all
k_place:
    s_lshl_b32 s22, s3, 10
    s_add_u32 s22, s22, 112640
    s_add_u32 s23, s92, 14336
    s_add_u32 s10, s91, 31
    s_lshr_b32 s10, s10, 5
    s_add_u32 s91, s91, 35952
    v_add_lshl_u32 v28, s91, v1, 2
    v_mov_b32 v29, 2130731432
    v_mov_b32 v31, 0
    ds_write_b32 v28, v29 offset:8192
    s_mov_b64 exec, s[18:19]
    ds_write2st64_b32 v28, v31, v31 offset0:0 offset1:8
    ds_write_b32 v28, v31 offset:4096
    s_mov_b64 exec, -1
    s_cmp_eq_u32 s21, 0
    s_cbranch_scc1 k_placed
    s_cmp_le_u32 s21, 2
    s_cbranch_scc1 k_p0
    ds_bpermute_b32 v85, v83, v30
    ds_bpermute_b32 v93, v91, v30
    s_waitcnt lgkmcnt(0)
    v_add_lshl_u32 v85, v85, v84, 2
    s_mov_b64 exec, s[72:73]
    ds_write_b32 v85, v86 offset:8192
    s_and_b64 exec, exec, s[18:19]
    ds_write2st64_b32 v85, v80, v81 offset0:0 offset1:8
    ds_write_b32 v85, v82 offset:4096
    s_mov_b64 exec, -1
    v_add_lshl_u32 v93, v93, v92, 2
    s_mov_b64 exec, s[74:75]
    ds_write_b32 v93, v94 offset:8192
    s_and_b64 exec, exec, s[18:19]
    ds_write2st64_b32 v93, v88, v89 offset0:0 offset1:8
    ds_write_b32 v93, v90 offset:4096
    s_mov_b64 exec, -1
    s_cmp_le_u32 s21, 3
    s_cbranch_scc1 k_p0
    ds_bpermute_b32 v101, v99, v30
    ds_bpermute_b32 v109, v107, v30
    s_waitcnt lgkmcnt(0)
    v_add_lshl_u32 v101, v101, v100, 2
    s_mov_b64 exec, s[76:77]
    ds_write_b32 v101, v102 offset:8192
    s_and_b64 exec, exec, s[18:19]
    ds_write2st64_b32 v101, v96, v97 offset0:0 offset1:8
    ds_write_b32 v101, v98 offset:4096
    s_mov_b64 exec, -1
    v_add_lshl_u32 v109, v109, v108, 2
    s_mov_b64 exec, s[78:79]
    ds_write_b32 v109, v110 offset:8192
    s_and_b64 exec, exec, s[18:19]
    ds_write2st64_b32 v109, v104, v105 offset0:0 offset1:8
    ds_write_b32 v109, v106 offset:4096
    s_mov_b64 exec, -1
    s_cmp_le_u32 s21, 4
    s_cbranch_scc1 k_p0
    ds_bpermute_b32 v117, v115, v30
    ds_bpermute_b32 v125, v123, v30
    s_waitcnt lgkmcnt(0)
    v_add_lshl_u32 v117, v117, v116, 2
    s_mov_b64 exec, s[80:81]
    ds_write_b32 v117, v118 offset:8192
    s_and_b64 exec, exec, s[18:19]
    ds_write2st64_b32 v117, v112, v113 offset0:0 offset1:8
    ds_write_b32 v117, v114 offset:4096
    s_mov_b64 exec, -1
    v_add_lshl_u32 v125, v125, v124, 2
    s_mov_b64 exec, s[82:83]
    ds_write_b32 v125, v126 offset:8192
    s_and_b64 exec, exec, s[18:19]
    ds_write2st64_b32 v125, v120, v121 offset0:0 offset1:8
    ds_write_b32 v125, v122 offset:4096
    s_mov_b64 exec, -1
k_p0:
    s_waitcnt lgkmcnt(0)
    v_add_lshl_u32 v53, v53, v52, 2
    s_mov_b64 exec, s[64:65]
    ds_write_b32 v53, v54 offset:8192
    s_and_b64 exec, exec, s[18:19]
    ds_write2st64_b32 v53, v48, v49 offset0:0 offset1:8
    ds_write_b32 v53, v50 offset:4096
    s_mov_b64 exec, -1
    v_add_lshl_u32 v61, v61, v60, 2
    s_mov_b64 exec, s[66:67]
    ds_write_b32 v61, v62 offset:8192
    s_and_b64 exec, exec, s[18:19]
    ds_write2st64_b32 v61, v56, v57 offset0:0 offset1:8
    ds_write_b32 v61, v58 offset:4096
    s_mov_b64 exec, -1
    v_add_lshl_u32 v69, v69, v68, 2
    s_mov_b64 exec, s[68:69]
    ds_write_b32 v69, v70 offset:8192
    s_and_b64 exec, exec, s[18:19]
    ds_write2st64_b32 v69, v64, v65 offset0:0 offset1:8
    ds_write_b32 v69, v66 offset:4096
    s_mov_b64 exec, -1
    v_add_lshl_u32 v77, v77, v76, 2
    s_mov_b64 exec, s[70:71]
    ds_write_b32 v77, v78 offset:8192
    s_and_b64 exec, exec, s[18:19]
    ds_write2st64_b32 v77, v72, v73 offset0:0 offset1:8
    ds_write_b32 v77, v74 offset:4096
    s_mov_b64 exec, -1
k_placed:
    s_xor_b32 s90, s3, 7
    s_or_b32 s90, s90, s89
    s_cbranch_scc1 k_hok
    s_waitcnt vmcnt(0)
k_hpoll:
    s_memrealtime s[6:7]
    v_subrev_u32 v44, s100, v40
    v_subrev_u32 v45, s100, v41
    v_subrev_u32 v46, s100, v42
    v_subrev_u32 v47, s100, v43
    v_max3_u32 v44, v44, v45, v46
    v_max_u32 v44, v44, v47
    s_waitcnt lgkmcnt(0)
    s_lshr_b64 s[6:7], s[6:7], 6
    s_sub_u32 s6, s6, s100
    s_add_u32 s7, s6, 3
    v_cmp_le_u32 vcc, s7, v44
    s_cbranch_vccz k_hok
    s_cmp_gt_u32 s6, 400
    s_cbranch_scc1 k_htmo
    s_sleep 2
    buffer_load_dwordx4 v[40:43], v2, s[52:55], s8 offen sc1
    s_waitcnt vmcnt(0)
    s_branch k_hpoll
k_htmo:
    v_mov_b32 v44, 162560
    ds_write_b32 v44, v21 offset:40
k_hok:
    s_lshl_b32 s64, s56, 16
    s_and_b32 s65, s56, 0xffff0000
    s_lshl_b32 s66, s57, 16
    s_and_b32 s67, s57, 0xffff0000
    s_lshl_b32 s68, s58, 16
    s_and_b32 s69, s58, 0xffff0000
    s_lshl_b32 s70, s59, 16
    s_and_b32 s71, s59, 0xffff0000
    s_lshl_b32 s72, s60, 16
    s_and_b32 s73, s60, 0xffff0000
    s_lshl_b32 s74, s61, 16
    s_and_b32 s75, s61, 0xffff0000
    s_lshl_b32 s76, s62, 16
    s_and_b32 s77, s62, 0xffff0000
    s_lshl_b32 s78, s63, 16
    s_and_b32 s79, s63, 0xffff0000
    v_readlane_b32 s8, v22, 0
    s_mov_b32 s11, -1
    s_mov_b32 s12, 0
    s_mov_b32 s9, 0
    s_mov_b32 s13, 0
    s_mov_b32 s17, 2
    s_mov_b32 s86, 2
    v_mov_b32 v23, v24
    v_add_u32 v32, s22, v2
    v_add_u32 v33, s23, v2
    s_mov_b32 s16, s98
    s_lshl_b32 s14, s3, 12
    s_mov_b32 s15, 65536
    v_mov_b32 v5, v36
    v_mov_b32 v20, v37
    v_mov_b32 v29, 162560
    s_waitcnt lgkmcnt(0)
    s_barrier
    ds_read_b32 v29, v29 offset:40
    s_waitcnt lgkmcnt(0)
    v_cmp_ne_u32 vcc, 0, v29
    s_cbranch_vccnz k_hfb
k_hdone:
    s_mov_b32 s20, 0
    s_movk_i32 s6, 14336
    s_cmp_lg_u32 s18, 0
    s_cbranch_scc1 k_nopl
    s_add_u32 s90, s93, s20
    s_cmp_ge_u32 s90, s10
    s_cbranch_scc1 pl_7
    s_lshl_b32 s90, s20, 7
    v_add_u32 v40, s90, v25
    ds_read_b32 v148, v40 offset:8192
    s_waitcnt lgkmcnt(0)
    v_and_b32 v41, 0xffffff, v148
    v_lshrrev_b32 v42, 28, v148
    v_lshrrev_b32 v148, 24, v148
    v_lshlrev_b32 v42, 1, v42
    v_sub_u32 v42, v148, v42
    v_add_u32 v42, s94, v42
    v_mul_u32_u24 v43, 6, v41
    v_mul_u32_u24 v44, 6, v42
    v_and_b32 v43, -4, v43
    v_and_b32 v44, -4, v44
    buffer_load_dwordx2 v[150:151], v43, s[32:35], 0 offen
    buffer_load_dwordx2 v[152:153], v44, s[32:35], 0 offen
    v_lshlrev_b32 v154, 4, v41
    v_lshlrev_b32 v155, 4, v42
pl_7:
k_nopl:
    s_cmp_le_u32 s10, 0
    s_cbranch_scc1 k_pre1
    ds_read_b32 v28, v5
    v_add_u32 v5, 128, v5
    s_waitcnt lgkmcnt(0)
    v_lshl_add_u32 v29, v28, 10, v3
    v_lshl_add_u32 v30, v28, 8, v4
    s_add_u32 m0, s14, 3072
    s_nop 0
    buffer_load_dwordx4 v30, s[40:43], 0 offen sc1 lds
    s_mov_b32 m0, s14
    s_nop 0
    buffer_load_dwordx4 v29, s[28:31], 0 offen lds
    s_add_u32 m0, s14, 768
    s_nop 0
    buffer_load_dwordx4 v29, s[28:31], 0 offen offset:256 lds
    s_add_u32 m0, s14, 1536
    s_nop 0
    buffer_load_dwordx4 v29, s[28:31], 0 offen offset:512 lds
    s_add_u32 s14, s14, 32768
    s_cmp_ge_u32 s14, 98304
    s_cselect_b32 s90, 98304, 0
    s_sub_u32 s14, s14, s90
k_pre1:
    s_mov_b32 s91, s10
    s_branch k_geo
k_ginit:
    v_mov_b32 v132, 0
    v_mov_b32 v133, 0
    v_mov_b32 v134, 0
    v_mov_b32 v135, 0
    v_mov_b32 v136, 0
    v_mov_b32 v137, 0
    v_mov_b32 v138, 0
    v_mov_b32 v139, 0
    v_mov_b32 v140, 0
    v_mov_b32 v141, 0
    v_mov_b32 v142, 0
    v_mov_b32 v143, 0
    v_mov_b32 v144, 0
    v_mov_b32 v145, 0
    v_mov_b32 v146, 0
    v_mov_b32 v147, 0
    s_cmp_eq_u32 s8, s9
    s_cbranch_scc1 k_adv
k_tile_next:
    s_add_u32 s11, s11, 1
    s_add_u32 s12, s12, 32
    s_and_b32 s90, s11, 15
    s_cbranch_scc1 k_tile
    s_cmp_eq_u32 s11, 0
    s_cbranch_scc1 k_tile
    s_waitcnt lgkmcnt(0)
    s_barrier
    s_mov_b32 s20, s11
    s_mov_b32 s18, 0
    s_add_u32 s90, s93, s20
    s_cmp_ge_u32 s90, s10
    s_cbranch_scc1 pl_8
    s_lshl_b32 s90, s20, 7
    v_add_u32 v40, s90, v25
    ds_read_b32 v148, v40 offset:8192
    s_waitcnt lgkmcnt(0)
    v_and_b32 v41, 0xffffff, v148
    v_lshrrev_b32 v42, 28, v148
    v_lshrrev_b32 v148, 24, v148
    v_lshlrev_b32 v42, 1, v42
    v_sub_u32 v42, v148, v42
    v_add_u32 v42, s94, v42
    v_mul_u32_u24 v43, 6, v41
    v_mul_u32_u24 v44, 6, v42
    v_and_b32 v43, -4, v43
    v_and_b32 v44, -4, v44
    buffer_load_dwordx2 v[150:151], v43, s[32:35], 0 offen
    buffer_load_dwordx2 v[152:153], v44, s[32:35], 0 offen
    v_lshlrev_b32 v154, 4, v41
    v_lshlrev_b32 v155, 4, v42
pl_8:
    s_mov_b32 s91, 0
k_geo:
    s_cmp_lg_u32 s18, 0
    s_cbranch_scc1 k_gl
    s_waitcnt vmcnt(4)
    s_cmp_lg_u32 s91, 0
    s_cbranch_scc1 k_gw
    s_waitcnt vmcnt(0)
k_gw:
    s_add_u32 s90, s93, s20
    s_cmp_ge_u32 s90, s10
    s_cbranch_scc1 k_gskip
    v_alignbit_b32 v46, v151, v150, v154
    v_lshrrev_b32 v47, v154, v151
    v_lshlrev_b32 v40, 16, v46
    v_and_b32 v41, 0xffff0000, v46
    v_lshlrev_b32 v42, 16, v47
    v_alignbit_b32 v46, v153, v152, v155
    v_lshrrev_b32 v47, v155, v153
    v_lshlrev_b32 v43, 16, v46
    v_and_b32 v44, 0xffff0000, v46
    v_lshlrev_b32 v45, 16, v47
    v_sub_f32 v40, v40, v43
    v_sub_f32 v41, v41, v44
    v_sub_f32 v42, v42, v45
    s_branch k_gc
k_gl:
    s_cmp_ge_u32 s93, s10
    s_cbranch_scc1 k_gskip
    ds_read2st64_b32 v[40:41], v25 offset0:0 offset1:8
    ds_read2st64_b32 v[42:43], v25 offset0:16 offset1:32
    s_waitcnt lgkmcnt(0)
    v_lshrrev_b32 v148, 24, v43
k_gc:
    v_cvt_pk_bf16_f32 v40, 0, v40
    v_cvt_pk_bf16_f32 v41, 0, v41
    v_cvt_pk_bf16_f32 v42, 0, v42
    v_mul_f32 v43, v40, v40
    v_mul_f32 v44, v41, v41
    v_mul_f32 v45, v42, v42
    v_cvt_pk_bf16_f32 v43, 0, v43
    v_cvt_pk_bf16_f32 v44, 0, v44
    v_cvt_pk_bf16_f32 v45, 0, v45
    v_add_f32 v48, v43, v44
    v_add_f32 v48, v48, v45
    v_cvt_pk_bf16_f32 v48, 0, v48
    v_add_f32 v48, 0x322bcc77, v48
    v_cvt_pk_bf16_f32 v48, 0, v48
    v_sqrt_f32 v48, v48
    ds_write_b16 v26, v148
    v_cvt_pk_bf16_f32 v48, 0, v48
    v_rcp_f32 v49, v48
    v_mul_f32 v50, 0x40490fdb, v48
    v_mul_f32 v64, s64, v48
    v_mul_f32 v65, s65, v48
    v_mul_f32 v66, s66, v48
    v_mul_f32 v67, s67, v48
    v_mul_f32 v68, s68, v48
    v_mul_f32 v69, s69, v48
    v_mul_f32 v70, s70, v48
    v_mul_f32 v71, s71, v48
    v_mul_f32 v72, s72, v48
    v_mul_f32 v73, s73, v48
    v_mul_f32 v74, s74, v48
    v_mul_f32 v75, s75, v48
    v_mul_f32 v76, s76, v48
    v_mul_f32 v77, s77, v48
    v_mul_f32 v78, s78, v48
    v_mul_f32 v79, s79, v48
    v_cvt_pk_bf16_f32 v50, 0, v50
    v_mul_f32 v50, 0x3e4ccccd, v50
    v_cvt_pk_bf16_f32 v50, 0, v50
    v_mul_f32 v50, 0.15915494, v50
    v_cos_f32 v50, v50
    v_mul_f32 v40, v40, v49
    v_mul_f32 v41, v41, v49
    v_mul_f32 v42, v42, v49
    v_cvt_pk_bf16_f32 v50, 0, v50
    v_cvt_pk_bf16_f32 v40, 0, v40
    v_cvt_pk_bf16_f32 v41, 0, v41
    v_cvt_pk_bf16_f32 v42, 0, v42
    ds_write_b32 v25, v40 offset:0
    ds_write_b32 v25, v41 offset:2048
    ds_write_b32 v25, v42 offset:4096
    v_add_f32 v50, 1.0, v50
    v_cvt_pk_bf16_f32 v50, 0, v50
    v_cmp_gt_f32 vcc, 0x40a00000, v48
    v_mul_f32 v50, 0.5, v50
    v_cvt_pk_bf16_f32 v64, 0, v64
    v_cvt_pk_bf16_f32 v65, 0, v65
    v_cvt_pk_bf16_f32 v66, 0, v66
    v_cvt_pk_bf16_f32 v67, 0, v67
    v_cvt_pk_bf16_f32 v68, 0, v68
    v_cvt_pk_bf16_f32 v69, 0, v69
    v_cvt_pk_bf16_f32 v70, 0, v70
    v_cvt_pk_bf16_f32 v71, 0, v71
    v_cvt_pk_bf16_f32 v72, 0, v72
    v_cvt_pk_bf16_f32 v73, 0, v73
    v_cvt_pk_bf16_f32 v74, 0, v74
    v_cvt_pk_bf16_f32 v75, 0, v75
    v_cvt_pk_bf16_f32 v76, 0, v76
    v_cvt_pk_bf16_f32 v77, 0, v77
    v_cvt_pk_bf16_f32 v78, 0, v78
    v_cvt_pk_bf16_f32 v79, 0, v79
    v_cndmask_b32 v50, 0, v50, vcc
    v_mul_f32 v49, v49, v50
    v_mul_f32 v64, 0.15915494, v64
    v_mul_f32 v65, 0.15915494, v65
    v_mul_f32 v66, 0.15915494, v66
    v_mul_f32 v67, 0.15915494, v67
    v_mul_f32 v68, 0.15915494, v68
    v_mul_f32 v69, 0.15915494, v69
    v_mul_f32 v70, 0.15915494, v70
    v_mul_f32 v71, 0.15915494, v71
    v_mul_f32 v72, 0.15915494, v72
    v_mul_f32 v73, 0.15915494, v73
    v_mul_f32 v74, 0.15915494, v74
    v_mul_f32 v75, 0.15915494, v75
    v_mul_f32 v76, 0.15915494, v76
    v_mul_f32 v77, 0.15915494, v77
    v_mul_f32 v78, 0.15915494, v78
    v_mul_f32 v79, 0.15915494, v79
    v_fract_f32 v64, v64
    v_fract_f32 v65, v65
    v_fract_f32 v66, v66
    v_fract_f32 v67, v67
    v_fract_f32 v68, v68
    v_fract_f32 v69, v69
    v_fract_f32 v70, v70
    v_fract_f32 v71, v71
    v_fract_f32 v72, v72
    v_fract_f32 v73, v73
    v_fract_f32 v74, v74
    v_fract_f32 v75, v75
    v_fract_f32 v76, v76
    v_fract_f32 v77, v77
    v_fract_f32 v78, v78
    v_fract_f32 v79, v79
    v_sin_f32 v64, v64
    v_sin_f32 v65, v65
    v_sin_f32 v66, v66
    v_sin_f32 v67, v67
    v_sin_f32 v68, v68
    v_sin_f32 v69, v69
    v_sin_f32 v70, v70
    v_sin_f32 v71, v71
    v_sin_f32 v72, v72
    v_sin_f32 v73, v73
    v_sin_f32 v74, v74
    v_sin_f32 v75, v75
    v_sin_f32 v76, v76
    v_sin_f32 v77, v77
    v_sin_f32 v78, v78
    v_sin_f32 v79, v79
    v_cvt_pk_bf16_f32 v64, 0, v64
    v_cvt_pk_bf16_f32 v65, 0, v65
    v_cvt_pk_bf16_f32 v66, 0, v66
    v_cvt_pk_bf16_f32 v67, 0, v67
    v_cvt_pk_bf16_f32 v68, 0, v68
    v_cvt_pk_bf16_f32 v69, 0, v69
    v_cvt_pk_bf16_f32 v70, 0, v70
    v_cvt_pk_bf16_f32 v71, 0, v71
    v_cvt_pk_bf16_f32 v72, 0, v72
    v_cvt_pk_bf16_f32 v73, 0, v73
    v_cvt_pk_bf16_f32 v74, 0, v74
    v_cvt_pk_bf16_f32 v75, 0, v75
    v_cvt_pk_bf16_f32 v76, 0, v76
    v_cvt_pk_bf16_f32 v77, 0, v77
    v_cvt_pk_bf16_f32 v78, 0, v78
    v_cvt_pk_bf16_f32 v79, 0, v79
    v_mul_f32 v64, v64, v49
    v_mul_f32 v65, v65, v49
    v_mul_f32 v66, v66, v49
    v_mul_f32 v67, v67, v49
    v_mul_f32 v68, v68, v49
    v_mul_f32 v69, v69, v49
    v_mul_f32 v70, v70, v49
    v_mul_f32 v71, v71, v49
    v_mul_f32 v72, v72, v49
    v_mul_f32 v73, v73, v49
    v_mul_f32 v74, v74, v49
    v_mul_f32 v75, v75, v49
    v_mul_f32 v76, v76, v49
    v_mul_f32 v77, v77, v49
    v_mul_f32 v78, v78, v49
    v_mul_f32 v79, v79, v49
    v_cvt_pk_bf16_f32 v80, v64, v65
    v_cvt_pk_bf16_f32 v81, v66, v67
    v_cvt_pk_bf16_f32 v82, v68, v69
    v_cvt_pk_bf16_f32 v83, v70, v71
    v_cvt_pk_bf16_f32 v84, v72, v73
    v_cvt_pk_bf16_f32 v85, v74, v75
    v_cvt_pk_bf16_f32 v86, v76, v77
    v_cvt_pk_bf16_f32 v87, v78, v79
    ds_write2_b64 v27, v[80:81], v[82:83] offset0:0 offset1:32
    ds_write2_b64 v27, v[84:85], v[86:87] offset0:64 offset1:96
k_gskip:
    v_mov_b32 v18, v34
    v_mov_b32 v19, v35
    s_cmp_ge_i32 s11, 0
    s_cbranch_scc1 k_geo2
    s_cmp_le_u32 s10, 1
    s_cbranch_scc1 k_geo1
    ds_read_b32 v28, v5
    v_add_u32 v5, 128, v5
    s_waitcnt lgkmcnt(0)
    v_lshl_add_u32 v29, v28, 10, v3
    v_lshl_add_u32 v30, v28, 8, v4
    s_add_u32 m0, s14, 3072
    s_nop 0
    buffer_load_dwordx4 v30, s[40:43], 0 offen sc1 lds
    s_mov_b32 m0, s14
    s_nop 0
    buffer_load_dwordx4 v29, s[28:31], 0 offen lds
    s_add_u32 m0, s14, 768
    s_nop 0
    buffer_load_dwordx4 v29, s[28:31], 0 offen offset:256 lds
    s_add_u32 m0, s14, 1536
    s_nop 0
    buffer_load_dwordx4 v29, s[28:31], 0 offen offset:512 lds
    s_add_u32 s14, s14, 32768
    s_cmp_ge_u32 s14, 98304
    s_cselect_b32 s90, 98304, 0
    s_sub_u32 s14, s14, s90
    s_waitcnt vmcnt(4)
    s_branch k_geo0
k_geo1:
    s_waitcnt vmcnt(0)
k_geo0:
    s_waitcnt lgkmcnt(0)
    s_barrier
    s_add_u32 s15, s15, 32768
    s_cmp_ge_u32 s15, 98304
    s_cselect_b32 s15, 0, s15
    v_add_u32 v13, s15, v8
    v_add_u32 v14, s15, v9
    v_add_u32 v15, s15, v10
    v_add_u32 v16, s15, v11
    v_add_u32 v17, s15, v12
    v_add_u32 v18, 1024, v18
    ds_read_b128 a[88:91], v18
    ds_read_b128 a[56:59], v13 offset:0
    ds_read_b128 a[72:75], v13 offset:16384
    ds_read_b128 a[60:63], v14 offset:0
    ds_read_b128 a[76:79], v14 offset:16384
    ds_read_b128 a[64:67], v15 offset:0
    ds_read_b128 a[80:83], v15 offset:16384
    ds_read_b128 a[68:71], v16 offset:0
    ds_read_b128 a[84:87], v16 offset:16384
    ds_read_b64_tr_b16 v[88:89], v17 offset:0
    ds_read_b64_tr_b16 v[90:91], v17 offset:16384
    ds_read_b64_tr_b16 v[92:93], v17 offset:1024
    ds_read_b64_tr_b16 v[94:95], v17 offset:17408
    ds_read_b64_tr_b16 v[96:97], v17 offset:2048
    ds_read_b64_tr_b16 a[54:55], v17 offset:18432
    s_branch k_ginit
k_geo2:
    s_waitcnt lgkmcnt(0)
    s_barrier
    v_add_u32 v18, 1024, v18
    ds_read_b128 a[88:91], v18
k_tile:
    v_add_u32 v19, 128, v19
    ds_read_b128 v[124:127], v19 offset:6144
    ds_read_b32 v28, v5
    v_add_u32 v5, 128, v5
    ds_read_b128 v[100:103], v19 offset:0
    ds_read_b128 v[104:107], v19 offset:64
    ds_read_b128 v[108:111], v19 offset:2048
    ds_read_b128 v[112:115], v19 offset:2112
    ds_read_b128 v[116:119], v19 offset:4096
    ds_read_b128 v[120:123], v19 offset:4160
    s_cmp_eq_u32 s17, 2
    s_cbranch_scc1 k_b1
    s_waitcnt vmcnt(4)
    s_cmp_eq_u32 s17, 1
    s_cbranch_scc1 k_b1
    s_waitcnt vmcnt(0)
k_b1:
    s_waitcnt lgkmcnt(8)
    s_barrier
    ds_read_b128 v[56:59], v32
    ds_read_b128 v[60:63], v33
    v_mfma_f32_16x16x16_bf16 v[64:67], a[88:89], a[52:53], 0
    s_cmp_eq_u32 s86, 1
    s_cselect_b64 s[24:25], -1, 0
    s_lshr_b64 s[26:27], s[24:25], 16
    s_sub_u32 s90, s16, 14336
    s_add_u32 s97, s16, 14336
    s_cmp_ge_u32 s13, 6
    s_cselect_b32 s97, 25600000, s97
    s_add_u32 s15, s15, 32768
    s_cmp_ge_u32 s15, 98304
    s_cselect_b32 s15, 0, s15
    v_mfma_f32_16x16x16_bf16 v[68:71], a[90:91], a[52:53], 0
    v_add_u32 v13, s15, v8
    v_add_u32 v14, s15, v9
    v_add_u32 v15, s15, v10
    v_mfma_f32_16x16x32_bf16 v[40:43], a[56:59], a[32:35], 0
    s_sub_u32 s91, s10, s11
    s_cmp_eq_u32 s11, 0
    s_addc_u32 s91, s91, 0
    v_add_u32 v16, s15, v11
    v_add_u32 v17, s15, v12
    v_mfma_f32_16x16x32_bf16 v[44:47], a[72:75], a[32:35], 0
    s_cmp_gt_u32 s91, 3
    s_cselect_b64 vcc, -1, 0
    s_cselect_b32 s17, 1, 0
    s_waitcnt lgkmcnt(0)
    s_cmp_eq_u32 s86, 2
    s_cselect_b32 s86, 4, 0
    s_cbranch_scc1 k_co2
k_noco:
    v_mfma_f32_16x16x32_bf16 v[40:43], a[60:63], a[36:39], v[40:43]
    s_mov_b64 exec, s[24:25]
    buffer_store_dwordx4 v[56:59], v6, s[36:39], s90 offen sc1
    s_mov_b64 exec, -1
    v_lshl_add_u32 v29, v28, 10, v3
    v_lshl_add_u32 v30, v28, 8, v4
    v_mfma_f32_16x16x32_bf16 v[44:47], a[76:79], a[36:39], v[44:47]
    v_xor_b32 v128, v124, v20
    v_xor_b32 v129, v125, v20
    v_xor_b32 v130, v126, v20
    v_mfma_f32_16x16x32_bf16 v[40:43], a[64:67], a[40:43], v[40:43]
    v_xor_b32 v131, v127, v20
    v_pk_sub_u16 v128, s95, v128 clamp
    v_pk_sub_u16 v129, s95, v129 clamp
    v_mfma_f32_16x16x32_bf16 v[44:47], a[80:83], a[40:43], v[44:47]
    v_pk_sub_u16 v130, s95, v130 clamp
    v_pk_sub_u16 v131, s95, v131 clamp
    v_pk_mul_lo_u16 v128, s96, v128
    v_mfma_f32_16x16x32_bf16 v[40:43], a[68:71], a[44:47], v[40:43]
    s_mov_b64 exec, s[26:27]
    buffer_store_dwordx4 v[60:63], v7, s[36:39], s90 offen sc1
    s_mov_b64 exec, -1
    v_pk_mul_lo_u16 v129, s96, v129
    v_pk_mul_lo_u16 v130, s96, v130
    v_mfma_f32_16x16x32_bf16 v[44:47], a[84:87], a[44:47], v[44:47]
    v_pk_mul_lo_u16 v131, s96, v131
    v_mfma_f32_16x16x16_bf16 v[72:75], a[88:89], a[50:51], 0
    v_mfma_f32_16x16x16_bf16 v[76:79], a[90:91], a[50:51], 0
    s_mov_b32 m0, s22
    s_mov_b64 exec, s[24:25]
    buffer_load_dwordx4 v6, s[44:47], s97 offen lds
    s_mov_b64 exec, -1
    v_mfma_f32_16x16x32_bf16 v[48:51], a[56:59], a[16:19], 0
    v_mul_f32 v40, v40, v64
    v_mul_f32 v41, v41, v65
    v_mul_f32 v42, v42, v66
    v_mul_f32 v43, v43, v67
    v_mfma_f32_16x16x32_bf16 v[52:55], a[72:75], a[16:19], 0
    v_mul_f32 v44, v44, v68
    v_mul_f32 v45, v45, v69
    v_mul_f32 v46, v46, v70
    v_mul_f32 v47, v47, v71
    v_mfma_f32_16x16x32_bf16 v[48:51], a[60:63], a[20:23], v[48:51]
    ds_read_b64 v[66:67], v23 offset:256
    ds_read_b64 v[68:69], v23 offset:512
    ds_read_b64 v[70:71], v23 offset:768
    ds_read_b64 v[64:65], v23 offset:0
    v_mfma_f32_16x16x32_bf16 v[52:55], a[76:79], a[20:23], v[52:55]
    s_mov_b32 m0, s23
    s_mov_b64 exec, s[26:27]
    buffer_load_dwordx4 v7, s[44:47], s97 offen lds
    s_mov_b64 exec, -1
    v_mul_f32 v100, v100, v40
    v_mul_f32 v101, v101, v41
    v_mul_f32 v102, v102, v42
    v_mfma_f32_16x16x32_bf16 v[48:51], a[64:67], a[24:27], v[48:51]
    v_mul_f32 v103, v103, v43
    v_mul_f32 v104, v104, v44
    v_mul_f32 v105, v105, v45
    v_mul_f32 v106, v106, v46
    v_mfma_f32_16x16x32_bf16 v[52:55], a[80:83], a[24:27], v[52:55]
    v_mul_f32 v107, v107, v47
    v_mul_f32 v108, v108, v40
    v_mul_f32 v109, v109, v41
    v_mul_f32 v110, v110, v42
    v_mfma_f32_16x16x32_bf16 v[48:51], a[68:71], a[28:31], v[48:51]
    v_mul_f32 v111, v111, v43
    s_cbranch_vccz ds_9
    s_add_u32 m0, s14, 3072
    s_nop 0
    buffer_load_dwordx4 v30, s[40:43], 0 offen sc1 lds
ds_9:
    v_mul_f32 v112, v112, v44
    v_mul_f32 v113, v113, v45
    v_mfma_f32_16x16x32_bf16 v[52:55], a[84:87], a[28:31], v[52:55]
    v_mul_f32 v114, v114, v46
    v_mul_f32 v115, v115, v47
    v_mfma_f32_16x16x16_bf16 v[148:151], a[92:93], v[88:89], 0
    v_mul_f32 v116, v116, v40
    v_mul_f32 v117, v117, v41
    v_mul_f32 v118, v118, v42
    v_mfma_f32_16x16x16_bf16 v[152:155], a[92:93], v[90:91], 0
    v_mul_f32 v119, v119, v43
    v_mul_f32 v120, v120, v44
    v_mul_f32 v121, v121, v45
    v_mfma_f32_16x16x16_bf16 v[156:159], a[92:93], v[92:93], 0
    v_mul_f32 v122, v122, v46
    v_mul_f32 v123, v123, v47
    v_add_u32 v18, 1024, v18
    v_mfma_f32_16x16x16_bf16 v[88:91], a[92:93], v[94:95], 0
    s_cbranch_vccz ds_10
    s_mov_b32 m0, s14
    s_nop 0
    buffer_load_dwordx4 v29, s[28:31], 0 offen lds
ds_10:
    v_mul_f32 v48, v48, v72
    v_mul_f32 v49, v49, v73
    v_mfma_f32_16x16x16_bf16 v[92:95], a[92:93], v[96:97], 0
    v_mul_f32 v50, v50, v74
    v_mul_f32 v51, v51, v75
    v_mul_f32 v52, v52, v76
    v_mfma_f32_16x16x16_bf16 v[96:99], a[92:93], a[54:55], 0
    v_mul_f32 v53, v53, v77
    v_mul_f32 v54, v54, v78
    v_mul_f32 v55, v55, v79
    v_mfma_f32_16x16x16_bf16 v[80:83], a[88:89], a[48:49], 0
    v_fmac_f32 v100, v48, v148
    v_fmac_f32 v101, v49, v149
    v_fmac_f32 v102, v50, v150
    v_mfma_f32_16x16x16_bf16 v[84:87], a[90:91], a[48:49], 0
    v_fmac_f32 v103, v51, v151
    s_cbranch_vccz ds_11
    s_add_u32 m0, s14, 768
    s_nop 0
    buffer_load_dwordx4 v29, s[28:31], 0 offen offset:256 lds
ds_11:
    v_fmac_f32 v104, v52, v152
    v_mfma_f32_16x16x32_bf16 v[56:59], a[56:59], a[0:3], 0
    v_fmac_f32 v105, v53, v153
    v_fmac_f32 v106, v54, v154
    v_fmac_f32 v107, v55, v155
    v_mfma_f32_16x16x32_bf16 v[60:63], a[72:75], a[0:3], 0
    ds_read_b128 a[88:91], v18
    v_cvt_pk_bf16_f32 v100, v100, v101
    v_cvt_pk_bf16_f32 v101, v102, v103
    v_mfma_f32_16x16x32_bf16 v[56:59], a[60:63], a[4:7], v[56:59]
    v_cvt_pk_bf16_f32 v102, v104, v105
    v_cvt_pk_bf16_f32 v103, v106, v107
    v_fmac_f32 v108, v48, v156
    v_mfma_f32_16x16x32_bf16 v[60:63], a[76:79], a[4:7], v[60:63]
    v_fmac_f32 v109, v49, v157
    v_fmac_f32 v110, v50, v158
    v_fmac_f32 v111, v51, v159
    v_mfma_f32_16x16x32_bf16 v[56:59], a[64:67], a[8:11], v[56:59]
    s_cbranch_vccz ds_12
    s_add_u32 m0, s14, 1536
    s_nop 0
    buffer_load_dwordx4 v29, s[28:31], 0 offen offset:512 lds
    s_add_u32 s14, s14, 32768
    s_cmp_ge_u32 s14, 98304
    s_cselect_b32 s90, 98304, 0
    s_sub_u32 s14, s14, s90
ds_12:
    v_fmac_f32 v112, v52, v88
    v_fmac_f32 v113, v53, v89
    v_mfma_f32_16x16x32_bf16 v[60:63], a[80:83], a[8:11], v[60:63]
    v_fmac_f32 v114, v54, v90
    v_fmac_f32 v115, v55, v91
    v_cvt_pk_bf16_f32 v108, v108, v109
    v_mfma_f32_16x16x32_bf16 v[56:59], a[68:71], a[12:15], v[56:59]
    v_cvt_pk_bf16_f32 v109, v110, v111
    v_cvt_pk_bf16_f32 v110, v112, v113
    v_cvt_pk_bf16_f32 v111, v114, v115
    v_mfma_f32_16x16x32_bf16 v[60:63], a[84:87], a[12:15], v[60:63]
    v_fmac_f32 v116, v48, v92
    v_fmac_f32 v117, v49, v93
    v_fmac_f32 v118, v50, v94
    s_cmp_eq_u32 s11, 0
    s_waitcnt lgkmcnt(0)
    s_cbranch_scc1 k_first
k_first_done:
    v_mfma_f32_16x16x32_bf16 v[136:139], v[100:103], v[128:131], v[136:139]
    ds_read_b128 a[56:59], v13 offset:0
    ds_read_b128 a[72:75], v13 offset:16384
    ds_read_b128 a[60:63], v14 offset:0
    ds_read_b128 a[76:79], v14 offset:16384
    v_fmac_f32 v119, v51, v95
    v_fmac_f32 v120, v52, v96
    v_fmac_f32 v121, v53, v97
    v_fmac_f32 v122, v54, v98
    v_mfma_f32_16x16x32_bf16 v[140:143], v[108:111], v[128:131], v[140:143]
    ds_read_b128 a[64:67], v15 offset:0
    ds_read_b128 a[80:83], v15 offset:16384
    ds_read_b128 a[68:71], v16 offset:0
    ds_read_b128 a[84:87], v16 offset:16384
    v_fmac_f32 v123, v55, v99
    v_cvt_pk_bf16_f32 v116, v116, v117
    v_cvt_pk_bf16_f32 v117, v118, v119
    v_cvt_pk_bf16_f32 v118, v120, v121
    v_cvt_pk_bf16_f32 v119, v122, v123
    v_mul_f32 v56, v56, v80
    v_mul_f32 v57, v57, v81
    v_mul_f32 v58, v58, v82
    v_mul_f32 v59, v59, v83
    v_mfma_f32_16x16x32_bf16 v[144:147], v[116:119], v[128:131], v[144:147]
    v_mul_f32 v60, v60, v84
    v_mul_f32 v61, v61, v85
    v_mul_f32 v62, v62, v86
    v_mul_f32 v63, v63, v87
    v_cvt_pk_bf16_f32 v56, v56, v57
    v_cvt_pk_bf16_f32 v57, v58, v59
    v_cvt_pk_bf16_f32 v58, v60, v61
    v_cvt_pk_bf16_f32 v59, v62, v63
    ds_read_b64_tr_b16 v[88:89], v17 offset:0
    ds_read_b64_tr_b16 v[90:91], v17 offset:16384
    v_mfma_f32_16x16x32_bf16 v[132:135], v[56:59], v[128:131], v[132:135]
    ds_read_b64_tr_b16 v[92:93], v17 offset:1024
    ds_read_b64_tr_b16 v[94:95], v17 offset:17408
    ds_read_b64_tr_b16 v[96:97], v17 offset:2048
    ds_read_b64_tr_b16 a[54:55], v17 offset:18432
k_setdone:
    s_cmp_gt_u32 s8, s12
    s_cbranch_scc1 k_tile_next
k_adv:
    s_cmp_lg_u32 s86, 0
    s_cbranch_scc1 k_slow
k_a1:
    v_add_u32 v20, 1048592, v20
    s_add_u32 s13, s13, 1
    s_mov_b32 s9, s8
    s_add_u32 s16, s16, 14336
    v_mfma_f32_16x16x16_bf16 v[136:139], a[92:93], v[66:67], v[136:139]
    v_readlane_b32 s8, v22, s13
    v_xor_b32 v128, v124, v20
    v_xor_b32 v129, v125, v20
    v_mfma_f32_16x16x16_bf16 v[140:143], a[92:93], v[68:69], v[140:143]
    v_xor_b32 v130, v126, v20
    v_xor_b32 v131, v127, v20
    v_pk_sub_u16 v128, s95, v128 clamp
    v_mfma_f32_16x16x16_bf16 v[144:147], a[92:93], v[70:71], v[144:147]
    v_pk_sub_u16 v129, s95, v129 clamp
    v_pk_sub_u16 v130, s95, v130 clamp
    v_pk_sub_u16 v131, s95, v131 clamp
    v_mfma_f32_16x16x16_bf16 v[132:135], a[92:93], v[64:65], v[132:135]
    v_pk_mul_lo_u16 v128, s96, v128
    v_pk_mul_lo_u16 v129, s96, v129
    v_pk_mul_lo_u16 v130, s96, v130
    v_pk_mul_lo_u16 v131, s96, v131
    s_mov_b32 s86, 1
    s_sub_u32 s6, 0, s6
    s_mov_b64 exec, s[84:85]
    v_cvt_pk_bf16_f32 v74, v136, v137
    v_cvt_pk_bf16_f32 v75, v138, v139
    ds_write_b64 v23, v[74:75] offset:256
    v_cvt_pk_bf16_f32 v76, v140, v141
    v_cvt_pk_bf16_f32 v77, v142, v143
    ds_write_b64 v23, v[76:77] offset:512
    v_cvt_pk_bf16_f32 v78, v144, v145
    v_cvt_pk_bf16_f32 v79, v146, v147
    ds_write_b64 v23, v[78:79] offset:768
    v_cvt_pk_bf16_f32 v72, v132, v133
    v_cvt_pk_bf16_f32 v73, v134, v135
    ds_write_b64 v23, v[72:73] offset:0
    s_mov_b64 exec, -1
    s_add_u32 s22, s22, s6
    s_add_u32 s23, s23, s6
    v_subrev_u32 v23, s6, v23
    v_add_u32 v32, s6, v32
    v_add_u32 v33, s6, v33
    s_cmp_ge_u32 s13, 7
    s_cbranch_scc1 k_fin
    s_cmp_eq_u32 s8, s9
    s_cbranch_scc1 k_ginit
    s_cmp_ge_u32 s9, s12
    s_cbranch_scc1 k_ginit
    v_mfma_f32_16x16x32_bf16 v[136:139], v[100:103], v[128:131], 0
    v_mfma_f32_16x16x32_bf16 v[140:143], v[108:111], v[128:131], 0
    v_mfma_f32_16x16x32_bf16 v[144:147], v[116:119], v[128:131], 0
    v_mfma_f32_16x16x32_bf16 v[132:135], v[56:59], v[128:131], 0
    s_branch k_setdone
k_first:
    s_waitcnt vmcnt(8)
    s_cmp_ge_u32 s10, 3
    s_cbranch_scc1 k_first1
    s_waitcnt vmcnt(4)
    s_cmp_eq_u32 s10, 2
    s_cbranch_scc1 k_first1
    s_waitcnt vmcnt(0)
k_first1:
    s_barrier
    s_mov_b32 s17, 0
    s_cmp_le_u32 s10, 3
    s_cbranch_scc1 k_first_done
    ds_read_b32 v28, v5
    v_add_u32 v5, 128, v5
    s_waitcnt lgkmcnt(0)
    v_lshl_add_u32 v29, v28, 10, v3
    v_lshl_add_u32 v30, v28, 8, v4
    s_add_u32 m0, s14, 3072
    s_nop 0
    buffer_load_dwordx4 v30, s[40:43], 0 offen sc1 lds
    s_mov_b32 m0, s14
    s_nop 0
    buffer_load_dwordx4 v29, s[28:31], 0 offen lds
    s_add_u32 m0, s14, 768
    s_nop 0
    buffer_load_dwordx4 v29, s[28:31], 0 offen offset:256 lds
    s_add_u32 m0, s14, 1536
    s_nop 0
    buffer_load_dwordx4 v29, s[28:31], 0 offen offset:512 lds
    s_add_u32 s14, s14, 32768
    s_cmp_ge_u32 s14, 98304
    s_cselect_b32 s90, 98304, 0
    s_sub_u32 s14, s14, s90
    s_mov_b32 s17, 1
    s_branch k_first_done
k_co2:
    s_add_u32 s90, s98, 14336
    s_add_u32 m0, s22, -14336
    s_nop 0
    buffer_load_dwordx4 v6, s[44:47], s98 offen lds
    s_add_u32 m0, s23, -14336
    s_mov_b32 exec_hi, 0xffff
    buffer_load_dwordx4 v7, s[44:47], s98 offen lds
    s_mov_b32 exec_hi, -1
    s_mov_b32 m0, s22
    s_nop 0
    buffer_load_dwordx4 v6, s[44:47], s90 offen lds
    s_mov_b32 m0, s23
    s_mov_b32 exec_hi, 0xffff
    buffer_load_dwordx4 v7, s[44:47], s90 offen lds
    s_mov_b32 exec_hi, -1
    s_branch k_noco
k_slow:
    s_cmp_lg_u32 s86, 2
    s_cbranch_scc1 k_sl0
    s_add_u32 s90, s98, 14336
    s_add_u32 m0, s22, -14336
    s_nop 0
    buffer_load_dwordx4 v6, s[44:47], s98 offen lds
    s_add_u32 m0, s23, -14336
    s_mov_b32 exec_hi, 0xffff
    buffer_load_dwordx4 v7, s[44:47], s98 offen lds
    s_mov_b32 exec_hi, -1
    s_mov_b32 m0, s22
    s_nop 0
    buffer_load_dwordx4 v6, s[44:47], s90 offen lds
    s_mov_b32 m0, s23
    s_mov_b32 exec_hi, 0xffff
    buffer_load_dwordx4 v7, s[44:47], s90 offen lds
    s_mov_b32 exec_hi, -1
k_sl0:
    s_waitcnt vmcnt(0) lgkmcnt(0)
    s_barrier
    ds_read_b64 v[66:67], v23 offset:256
    ds_read_b64 v[68:69], v23 offset:512
    ds_read_b64 v[70:71], v23 offset:768
    ds_read_b64 v[64:65], v23 offset:0
    ds_read_b128 v[148:151], v32
    ds_read_b128 v[152:155], v33
    s_mov_b32 s17, 0
    s_cmp_lg_u32 s86, 1
    s_cbranch_scc1 k_sl1
    s_sub_u32 s90, s16, 14336
    s_add_u32 s97, s16, 14336
    s_waitcnt lgkmcnt(0)
    buffer_store_dwordx4 v[148:151], v6, s[36:39], s90 offen sc1
    s_mov_b32 m0, s23
    s_mov_b32 exec_hi, 0xffff
    buffer_store_dwordx4 v[152:155], v7, s[36:39], s90 offen sc1
    s_cmp_ge_u32 s13, 6
    s_cbranch_scc1 k_sl1
    buffer_load_dwordx4 v7, s[44:47], s97 offen lds
    s_mov_b32 m0, s22
    s_mov_b32 exec_hi, -1
    buffer_load_dwordx4 v6, s[44:47], s97 offen lds
k_sl1:
    s_mov_b32 exec_hi, -1
    s_waitcnt lgkmcnt(0)
    s_branch k_a1
k_fin:
    s_waitcnt lgkmcnt(0)
    s_barrier
    ds_read_b128 v[148:151], v32
    ds_read_b128 v[152:155], v33
    s_sub_u32 s90, s16, 14336
    s_add_u32 s97, s16, 14336
    s_waitcnt lgkmcnt(0)
    buffer_store_dwordx4 v[148:151], v6, s[36:39], s90 offen sc1
    s_mov_b32 m0, s23
    s_mov_b32 exec_hi, 0xffff
    buffer_store_dwordx4 v[152:155], v7, s[36:39], s90 offen sc1
    s_cmp_ge_u32 s13, 6
    s_cbranch_scc1 k_fin1
    buffer_load_dwordx4 v7, s[44:47], s97 offen lds
    s_mov_b32 m0, s22
    s_mov_b32 exec_hi, -1
    buffer_load_dwordx4 v6, s[44:47], s97 offen lds
k_fin1:
    s_mov_b32 exec_hi, -1
    s_cmp_eq_u32 s88, 0
    s_cbranch_scc1 k_exit
    s_cmp_lg_u32 s89, 0
    s_cbranch_scc1 k_ovf_next
    s_mov_b32 s89, 1
    s_mov_b32 s4, -1
    s_mov_b32 s5, 0
    s_mov_b32 s44, s36
    s_mov_b32 s45, s37
    s_mov_b32 s46, 25600000
    s_mov_b32 s47, 0x00020000
k_ovf_next:
    s_cmp_lg_u32 s5, 0
    s_cbranch_scc1 k_ovf_blk
    s_add_u32 s4, s4, 1
    s_cmp_ge_u32 s4, 128
    s_cbranch_scc1 k_exit
    s_lshl_b32 s90, s4, 2
    s_add_u32 s90, s90, 162624
    v_mov_b32 v40, s90
    ds_read_b32 v40, v40
    s_waitcnt lgkmcnt(0)
    v_cmp_ne_u32 vcc, 0, v40
    s_cbranch_vccz k_ovf_next
k_ovf_blk:
    s_load_dwordx4 s[72:75], s[0:1], 16
    s_waitcnt lgkmcnt(0)
    s_barrier
    v_and_b32 v44, 15, v1
    s_mov_b32 s7, 162560
    v_lshl_add_u32 v45, v44, 2, s7
    v_mov_b32 v46, 0
    ds_write_b32 v45, v46
    s_mul_i32 s90, s4, 12500
    s_add_u32 s91, s90, 12500
    s_add_u32 s90, s90, s5
    s_mov_b32 s76, s72
    s_mov_b32 s77, s73
    s_mov_b32 s78, s91
    s_mov_b32 s79, 0x00020000
    s_mov_b32 s80, s74
    s_mov_b32 s81, s75
    s_mov_b32 s82, s91
    s_mov_b32 s83, 0x00020000
    v_lshlrev_b32 v128, 4, v0
    buffer_load_dwordx4 v[40:43], v128, s[76:79], s90 offen
    buffer_load_dwordx4 v[44:47], v128, s[80:83], s90 offen
    s_sub_u32 s91, s91, s90
    s_xor_b32 s5, s5, 8192
    s_movk_i32 s90, 147
    s_mov_b32 s21, 2
    s_waitcnt vmcnt(0) lgkmcnt(0)
    s_barrier
    v_add_u32 v48, 0, v128
    v_cmp_gt_u32 s[72:73], s91, v48
    v_subrev_u32 v48, s94, v44
    v_cmp_gt_u32 vcc, 98, v48
    s_and_b64 s[64:65], s[72:73], vcc
    v_mul_u32_u24 v49, s90, v48
    v_bfe_u32 v49, v49, 11, 3
    v_lshl_add_u32 v48, v49, 1, v48
    v_lshl_or_b32 v54, v48, 24, v40
    v_lshl_add_u32 v51, v49, 2, s7
    s_mov_b64 exec, s[64:65]
    ds_add_rtn_u32 v52, v51, v21
    s_mov_b64 exec, -1
    v_add_u32 v56, 4, v128
    v_cmp_gt_u32 s[72:73], s91, v56
    v_subrev_u32 v56, s94, v45
    v_cmp_gt_u32 vcc, 98, v56
    s_and_b64 s[66:67], s[72:73], vcc
    v_mul_u32_u24 v57, s90, v56
    v_bfe_u32 v57, v57, 11, 3
    v_lshl_add_u32 v56, v57, 1, v56
    v_lshl_or_b32 v62, v56, 24, v41
    v_lshl_add_u32 v59, v57, 2, s7
    s_mov_b64 exec, s[66:67]
    ds_add_rtn_u32 v60, v59, v21
    s_mov_b64 exec, -1
    v_add_u32 v64, 8, v128
    v_cmp_gt_u32 s[72:73], s91, v64
    v_subrev_u32 v64, s94, v46
    v_cmp_gt_u32 vcc, 98, v64
    s_and_b64 s[68:69], s[72:73], vcc
    v_mul_u32_u24 v65, s90, v64
    v_bfe_u32 v65, v65, 11, 3
    v_lshl_add_u32 v64, v65, 1, v64
    v_lshl_or_b32 v70, v64, 24, v42
    v_lshl_add_u32 v67, v65, 2, s7
    s_mov_b64 exec, s[68:69]
    ds_add_rtn_u32 v68, v67, v21
    s_mov_b64 exec, -1
    v_add_u32 v72, 12, v128
    v_cmp_gt_u32 s[72:73], s91, v72
    v_subrev_u32 v72, s94, v47
    v_cmp_gt_u32 vcc, 98, v72
    s_and_b64 s[70:71], s[72:73], vcc
    v_mul_u32_u24 v73, s90, v72
    v_bfe_u32 v73, v73, 11, 3
    v_lshl_add_u32 v72, v73, 1, v72
    v_lshl_or_b32 v78, v72, 24, v43
    v_lshl_add_u32 v75, v73, 2, s7
    s_mov_b64 exec, s[70:71]
    ds_add_rtn_u32 v76, v75, v21
    s_mov_b64 exec, -1
    s_branch k_bin
k_hfb:
    s_mov_b32 s101, -98
k_hfb_next:
    s_add_u32 s101, s101, 98
    s_cmp_lt_u32 s101, 25000
    s_cbranch_scc1 k_hfb_go
    s_mov_b32 s30, 25600000
    s_mov_b32 s42, 6400000
    s_waitcnt vmcnt(0)
    s_barrier
    s_branch k_hdone
k_hfb_go:
    s_add_u32 s90, s101, 98
    s_min_u32 s90, s90, 25000
    s_lshl_b32 s30, s90, 10
    s_lshl_b32 s42, s90, 8
    s_lshl_b32 s91, s101, 10
    s_lshl_b32 s90, s3, 10
    s_cmp_lg_u32 s3, 0
    s_cbranch_scc1 sl_13
    s_mov_b32 m0, 57344
    s_add_u32 s97, s91, 98304
    buffer_load_dwordx4 v152, s[28:31], s97 offen lds
sl_13:
    s_add_u32 m0, s90, 32768
    s_nop 0
    buffer_load_dwordx4 v152, s[28:31], s91 offen lds
    s_add_u32 m0, s90, 40960
    s_add_u32 s91, s91, 32768
    buffer_load_dwordx4 v152, s[28:31], s91 offen lds
    s_add_u32 m0, s90, 49152
    s_add_u32 s91, s91, 32768
    buffer_load_dwordx4 v152, s[28:31], s91 offen lds
    s_waitcnt vmcnt(0)
    s_barrier
    ds_read_b128 a[56:59], v38 offset:0
    ds_read_b128 a[72:75], v38 offset:4096
    v_xor_b32 v157, 64, v38
    ds_read_b128 a[60:63], v157 offset:0
    ds_read_b128 a[76:79], v157 offset:4096
    v_xor_b32 v158, 128, v38
    ds_read_b128 a[64:67], v158 offset:0
    ds_read_b128 a[80:83], v158 offset:4096
    v_xor_b32 v159, 192, v38
    ds_read_b128 a[68:71], v159 offset:0
    ds_read_b128 a[84:87], v159 offset:4096
    ds_read_b64_tr_b16 v[72:73], v139 offset:0
    ds_read_b64_tr_b16 v[74:75], v139 offset:1024
    s_waitcnt lgkmcnt(0)
    ds_read_b64_tr_b16 v[76:77], v139 offset:8192
    ds_read_b64_tr_b16 v[78:79], v139 offset:9216
    ds_read_b64_tr_b16 v[80:81], v139 offset:16384
    ds_read_b64_tr_b16 v[82:83], v139 offset:17408
    ds_read_b64_tr_b16 v[84:85], v139 offset:24576
    ds_read_b64_tr_b16 v[86:87], v139 offset:25600
    v_xor_b32 v157, 32, v139
    ds_read_b64_tr_b16 v[88:89], v157 offset:0
    ds_read_b64_tr_b16 v[90:91], v157 offset:1024
    ds_read_b64_tr_b16 v[92:93], v157 offset:8192
    ds_read_b64_tr_b16 v[94:95], v157 offset:9216
    ds_read_b64_tr_b16 v[96:97], v157 offset:16384
    ds_read_b64_tr_b16 v[98:99], v157 offset:17408
    ds_read_b64_tr_b16 v[100:101], v157 offset:24576
    ds_read_b64_tr_b16 v[102:103], v157 offset:25600
    v_xor_b32 v158, 64, v139
    ds_read_b64_tr_b16 v[104:105], v158 offset:0
    ds_read_b64_tr_b16 v[106:107], v158 offset:1024
    ds_read_b64_tr_b16 v[108:109], v158 offset:8192
    ds_read_b64_tr_b16 v[110:111], v158 offset:9216
    ds_read_b64_tr_b16 v[112:113], v158 offset:16384
    ds_read_b64_tr_b16 v[114:115], v158 offset:17408
    ds_read_b64_tr_b16 v[116:117], v158 offset:24576
    ds_read_b64_tr_b16 v[118:119], v158 offset:25600
    v_xor_b32 v159, 96, v139
    ds_read_b64_tr_b16 v[120:121], v159 offset:0
    ds_read_b64_tr_b16 v[122:123], v159 offset:1024
    ds_read_b64_tr_b16 v[124:125], v159 offset:8192
    ds_read_b64_tr_b16 v[126:127], v159 offset:9216
    ds_read_b64_tr_b16 v[128:129], v159 offset:16384
    ds_read_b64_tr_b16 v[130:131], v159 offset:17408
    ds_read_b64_tr_b16 v[132:133], v159 offset:24576
    ds_read_b64_tr_b16 v[134:135], v159 offset:25600
    s_lshr_b32 s90, s3, 1
    s_lshl_b32 s90, s90, 5
    s_add_u32 s90, s90, s101
    s_lshl_b32 s90, s90, 8
    s_add_u32 s91, s90, 4096
    s_mov_b32 s7, 0xbfb8aa3b
    s_lshl_b32 s5, s3, 10
    v_mfma_f32_16x16x32_bf16 v[40:43], v[72:75], a[56:59], 0
    v_mfma_f32_16x16x32_bf16 v[56:59], v[72:75], a[72:75], 0
    s_waitcnt lgkmcnt(15)
    v_mfma_f32_16x16x32_bf16 v[40:43], v[76:79], a[60:63], v[40:43]
    v_mfma_f32_16x16x32_bf16 v[56:59], v[76:79], a[76:79], v[56:59]
    v_mfma_f32_16x16x32_bf16 v[40:43], v[80:83], a[64:67], v[40:43]
    v_mfma_f32_16x16x32_bf16 v[56:59], v[80:83], a[80:83], v[56:59]
    v_mfma_f32_16x16x32_bf16 v[40:43], v[84:87], a[68:71], v[40:43]
    v_mfma_f32_16x16x32_bf16 v[56:59], v[84:87], a[84:87], v[56:59]
    s_barrier
    v_mfma_f32_16x16x32_bf16 v[44:47], v[88:91], a[56:59], 0
    v_mfma_f32_16x16x32_bf16 v[60:63], v[88:91], a[72:75], 0
    v_mfma_f32_16x16x32_bf16 v[44:47], v[92:95], a[60:63], v[44:47]
    v_mfma_f32_16x16x32_bf16 v[60:63], v[92:95], a[76:79], v[60:63]
    v_mfma_f32_16x16x32_bf16 v[44:47], v[96:99], a[64:67], v[44:47]
    v_mfma_f32_16x16x32_bf16 v[60:63], v[96:99], a[80:83], v[60:63]
    v_mfma_f32_16x16x32_bf16 v[44:47], v[100:103], a[68:71], v[44:47]
    v_mfma_f32_16x16x32_bf16 v[60:63], v[100:103], a[84:87], v[60:63]
    s_waitcnt lgkmcnt(14)
    v_mfma_f32_16x16x32_bf16 v[48:51], v[104:107], a[56:59], 0
    v_mfma_f32_16x16x32_bf16 v[64:67], v[104:107], a[72:75], 0
    s_waitcnt lgkmcnt(12)
    v_mfma_f32_16x16x32_bf16 v[48:51], v[108:111], a[60:63], v[48:51]
    v_mfma_f32_16x16x32_bf16 v[64:67], v[108:111], a[76:79], v[64:67]
    s_waitcnt lgkmcnt(10)
    v_mfma_f32_16x16x32_bf16 v[48:51], v[112:115], a[64:67], v[48:51]
    v_mfma_f32_16x16x32_bf16 v[64:67], v[112:115], a[80:83], v[64:67]
    s_waitcnt lgkmcnt(8)
    v_mfma_f32_16x16x32_bf16 v[48:51], v[116:119], a[68:71], v[48:51]
    v_mfma_f32_16x16x32_bf16 v[64:67], v[116:119], a[84:87], v[64:67]
    s_waitcnt lgkmcnt(6)
    v_mfma_f32_16x16x32_bf16 v[52:55], v[120:123], a[56:59], 0
    v_mfma_f32_16x16x32_bf16 v[68:71], v[120:123], a[72:75], 0
    s_waitcnt lgkmcnt(4)
    v_mfma_f32_16x16x32_bf16 v[52:55], v[124:127], a[60:63], v[52:55]
    v_mfma_f32_16x16x32_bf16 v[68:71], v[124:127], a[76:79], v[68:71]
    s_waitcnt lgkmcnt(2)
    v_mfma_f32_16x16x32_bf16 v[52:55], v[128:131], a[64:67], v[52:55]
    v_mfma_f32_16x16x32_bf16 v[68:71], v[128:131], a[80:83], v[68:71]
    s_waitcnt lgkmcnt(0)
    v_mfma_f32_16x16x32_bf16 v[52:55], v[132:135], a[68:71], v[52:55]
    v_mfma_f32_16x16x32_bf16 v[68:71], v[132:135], a[84:87], v[68:71]
    v_mul_f32 v72, s7, v40
    v_mul_f32 v73, s7, v41
    v_mul_f32 v74, s7, v42
    v_mul_f32 v75, s7, v43
    v_mul_f32 v76, s7, v44
    v_mul_f32 v77, s7, v45
    v_mul_f32 v78, s7, v46
    v_mul_f32 v79, s7, v47
    v_mul_f32 v80, s7, v48
    v_mul_f32 v81, s7, v49
    v_mul_f32 v82, s7, v50
    v_mul_f32 v83, s7, v51
    v_mul_f32 v84, s7, v52
    v_mul_f32 v85, s7, v53
    v_mul_f32 v86, s7, v54
    v_mul_f32 v87, s7, v55
    v_exp_f32 v72, v72
    v_exp_f32 v73, v73
    v_exp_f32 v74, v74
    v_exp_f32 v75, v75
    v_exp_f32 v76, v76
    v_exp_f32 v77, v77
    v_exp_f32 v78, v78
    v_exp_f32 v79, v79
    v_exp_f32 v80, v80
    v_exp_f32 v81, v81
    v_exp_f32 v82, v82
    v_exp_f32 v83, v83
    v_exp_f32 v84, v84
    v_exp_f32 v85, v85
    v_exp_f32 v86, v86
    v_exp_f32 v87, v87
    v_add_f32 v72, 1.0, v72
    v_add_f32 v73, 1.0, v73
    v_add_f32 v74, 1.0, v74
    v_add_f32 v75, 1.0, v75
    v_add_f32 v76, 1.0, v76
    v_add_f32 v77, 1.0, v77
    v_add_f32 v78, 1.0, v78
    v_add_f32 v79, 1.0, v79
    v_add_f32 v80, 1.0, v80
    v_add_f32 v81, 1.0, v81
    v_add_f32 v82, 1.0, v82
    v_add_f32 v83, 1.0, v83
    v_add_f32 v84, 1.0, v84
    v_add_f32 v85, 1.0, v85
    v_add_f32 v86, 1.0, v86
    v_add_f32 v87, 1.0, v87
    v_rcp_f32 v72, v72
    v_rcp_f32 v73, v73
    v_rcp_f32 v74, v74
    v_rcp_f32 v75, v75
    v_rcp_f32 v76, v76
    v_rcp_f32 v77, v77
    v_rcp_f32 v78, v78
    v_rcp_f32 v79, v79
    v_rcp_f32 v80, v80
    v_rcp_f32 v81, v81
    v_rcp_f32 v82, v82
    v_rcp_f32 v83, v83
    v_rcp_f32 v84, v84
    v_rcp_f32 v85, v85
    v_rcp_f32 v86, v86
    v_rcp_f32 v87, v87
    v_mul_f32 v72, v72, v40
    v_mul_f32 v73, v73, v41
    v_mul_f32 v74, v74, v42
    v_mul_f32 v75, v75, v43
    v_mul_f32 v76, v76, v44
    v_mul_f32 v77, v77, v45
    v_mul_f32 v78, v78, v46
    v_mul_f32 v79, v79, v47
    v_mul_f32 v80, v80, v48
    v_mul_f32 v81, v81, v49
    v_mul_f32 v82, v82, v50
    v_mul_f32 v83, v83, v51
    v_mul_f32 v84, v84, v52
    v_mul_f32 v85, v85, v53
    v_mul_f32 v86, v86, v54
    v_mul_f32 v87, v87, v55
    v_cvt_pk_bf16_f32 v40, v72, v73
    v_cvt_pk_bf16_f32 v41, v74, v75
    v_cvt_pk_bf16_f32 v42, v76, v77
    v_cvt_pk_bf16_f32 v43, v78, v79
    v_cvt_pk_bf16_f32 v44, v80, v81
    v_cvt_pk_bf16_f32 v45, v82, v83
    v_cvt_pk_bf16_f32 v46, v84, v85
    v_cvt_pk_bf16_f32 v47, v86, v87
    v_permlane16_swap_b32 v40, v42
    v_permlane16_swap_b32 v41, v43
    v_permlane16_swap_b32 v44, v46
    v_permlane16_swap_b32 v45, v47
    buffer_store_dwordx4 v[40:43], v140, s[40:43], s90 offen offset:0 sc1
    buffer_store_dwordx4 v[44:47], v140, s[40:43], s90 offen offset:64 sc1
    s_cmp_ge_u32 s3, 6
    s_cbranch_scc1 n1_14
    v_mul_f32 v72, s7, v56
    v_mul_f32 v73, s7, v57
    v_mul_f32 v74, s7, v58
    v_mul_f32 v75, s7, v59
    v_mul_f32 v76, s7, v60
    v_mul_f32 v77, s7, v61
    v_mul_f32 v78, s7, v62
    v_mul_f32 v79, s7, v63
    v_mul_f32 v80, s7, v64
    v_mul_f32 v81, s7, v65
    v_mul_f32 v82, s7, v66
    v_mul_f32 v83, s7, v67
    v_mul_f32 v84, s7, v68
    v_mul_f32 v85, s7, v69
    v_mul_f32 v86, s7, v70
    v_mul_f32 v87, s7, v71
    v_exp_f32 v72, v72
    v_exp_f32 v73, v73
    v_exp_f32 v74, v74
    v_exp_f32 v75, v75
    v_exp_f32 v76, v76
    v_exp_f32 v77, v77
    v_exp_f32 v78, v78
    v_exp_f32 v79, v79
    v_exp_f32 v80, v80
    v_exp_f32 v81, v81
    v_exp_f32 v82, v82
    v_exp_f32 v83, v83
    v_exp_f32 v84, v84
    v_exp_f32 v85, v85
    v_exp_f32 v86, v86
    v_exp_f32 v87, v87
    v_add_f32 v72, 1.0, v72
    v_add_f32 v73, 1.0, v73
    v_add_f32 v74, 1.0, v74
    v_add_f32 v75, 1.0, v75
    v_add_f32 v76, 1.0, v76
    v_add_f32 v77, 1.0, v77
    v_add_f32 v78, 1.0, v78
    v_add_f32 v79, 1.0, v79
    v_add_f32 v80, 1.0, v80
    v_add_f32 v81, 1.0, v81
    v_add_f32 v82, 1.0, v82
    v_add_f32 v83, 1.0, v83
    v_add_f32 v84, 1.0, v84
    v_add_f32 v85, 1.0, v85
    v_add_f32 v86, 1.0, v86
    v_add_f32 v87, 1.0, v87
    v_rcp_f32 v72, v72
    v_rcp_f32 v73, v73
    v_rcp_f32 v74, v74
    v_rcp_f32 v75, v75
    v_rcp_f32 v76, v76
    v_rcp_f32 v77, v77
    v_rcp_f32 v78, v78
    v_rcp_f32 v79, v79
    v_rcp_f32 v80, v80
    v_rcp_f32 v81, v81
    v_rcp_f32 v82, v82
    v_rcp_f32 v83, v83
    v_rcp_f32 v84, v84
    v_rcp_f32 v85, v85
    v_rcp_f32 v86, v86
    v_rcp_f32 v87, v87
    v_mul_f32 v72, v72, v56
    v_mul_f32 v73, v73, v57
    v_mul_f32 v74, v74, v58
    v_mul_f32 v75, v75, v59
    v_mul_f32 v76, v76, v60
    v_mul_f32 v77, v77, v61
    v_mul_f32 v78, v78, v62
    v_mul_f32 v79, v79, v63
    v_mul_f32 v80, v80, v64
    v_mul_f32 v81, v81, v65
    v_mul_f32 v82, v82, v66
    v_mul_f32 v83, v83, v67
    v_mul_f32 v84, v84, v68
    v_mul_f32 v85, v85, v69
    v_mul_f32 v86, v86, v70
    v_mul_f32 v87, v87, v71
    v_cvt_pk_bf16_f32 v56, v72, v73
    v_cvt_pk_bf16_f32 v57, v74, v75
    v_cvt_pk_bf16_f32 v58, v76, v77
    v_cvt_pk_bf16_f32 v59, v78, v79
    v_cvt_pk_bf16_f32 v60, v80, v81
    v_cvt_pk_bf16_f32 v61, v82, v83
    v_cvt_pk_bf16_f32 v62, v84, v85
    v_cvt_pk_bf16_f32 v63, v86, v87
    v_permlane16_swap_b32 v56, v58
    v_permlane16_swap_b32 v57, v59
    v_permlane16_swap_b32 v60, v62
    v_permlane16_swap_b32 v61, v63
    buffer_store_dwordx4 v[56:59], v140, s[40:43], s91 offen offset:0 sc1
    buffer_store_dwordx4 v[60:63], v140, s[40:43], s91 offen offset:64 sc1
n1_14:
    s_branch k_hfb_next
k_exit:
    s_cmp_lg_u32 s3, 0
    s_cbranch_scc1 k_end
k_life:
    s_memrealtime s[6:7]
    s_waitcnt lgkmcnt(0)
    s_lshr_b64 s[6:7], s[6:7], 6
    s_sub_u32 s6, s6, s99
    s_cmp_ge_u32 s6, 36
    s_cbranch_scc1 k_end
    s_sleep 8
    s_branch k_life
k_end:
    s_endpgm
.section .rodata,"a"
.p2align 6
.amdhsa_kernel painn_fused_kernel
  .amdhsa_next_free_vgpr 256
  .amdhsa_next_free_sgpr 102
  .amdhsa_accum_offset 160
  .amdhsa_group_segment_fixed_size 0
  .amdhsa_kernarg_size 88
  .amdhsa_user_sgpr_count 2
  .amdhsa_user_sgpr_kernarg_segment_ptr 1
  .amdhsa_system_sgpr_workgroup_id_x 1
.end_amdhsa_kernel
```
